```python
import torch

def _softmax(x, axis=-1):
    return torch.softmax(x, dim=axis)
def _gelu(x):
    return torch.nn.functional.gelu(x, approximate="tanh")
def _silu(x):
    return torch.nn.functional.silu(x)
def _sigmoid(x):
    return torch.sigmoid(x)
def _layernorm(x, axis=-1, eps=1e-5):
    m = x.mean(dim=axis, keepdim=True)
    v = x.var(dim=axis, keepdim=True, unbiased=False)
    return (x - m) / torch.sqrt(v + eps)
def _scatter_add(tgt, idx, src, axis=0):
    return tgt.clone().index_add_(axis, idx, src)
def _segment_sum(src, seg, n):
    out = torch.zeros((n,) + src.shape[1:], dtype=src.dtype)
    return out.index_add_(0, seg, src)
def _pad(x, pw):
    flat = tuple(v for pair in reversed(pw) for v in pair)
    return torch.nn.functional.pad(x, flat)

kernel_name = 'sequential_preLN__sliding_local_dilated__glu_gated_geglu__prompt'

def setup_inputs():

    _w = (lambda a: (lambda t: t.to(torch.bfloat16) if t.is_floating_point() else t)(torch.as_tensor(a)))
    def _A_setup():
        B, S, D = 1, 2048, 640
        return {
            "x": _w((lambda *s: torch.randn(*s, dtype=torch.bfloat16) * 0.05)(B, S, D)),
            "wqkv": _w((lambda *s: torch.randn(*s, dtype=torch.bfloat16) * 0.05)(D, 3 * D)),
            "wo": _w((lambda *s: torch.randn(*s, dtype=torch.bfloat16) * 0.05)(D, D)),
        }
    _A_in = _A_setup()

    def _B_setup():
        B, S, Dm, Df = 1, 2048, 640, 1536
        return {
            "x": _w((lambda *s: torch.randn(*s, dtype=torch.bfloat16) * 0.05)(B, S, Dm)),
            "w_gate": _w((lambda *s: torch.randn(*s, dtype=torch.bfloat16) * 0.8)(Dm, Df) * (Dm ** -0.5)),
            "w_up": _w((lambda *s: torch.randn(*s, dtype=torch.bfloat16) * 0.8)(Dm, Df) * (Dm ** -0.5)),
            "w_down": _w((lambda *s: torch.randn(*s, dtype=torch.bfloat16) * 0.8)(Df, Dm) * (Df ** -0.5)),
        }
    _B_in = _B_setup()

    return {
        "A_x": _A_in["x"],
        "A_wqkv": _A_in["wqkv"],
        "A_wo": _A_in["wo"],
        "B_x": _B_in["x"],
        "B_w_gate": _B_in["w_gate"],
        "B_w_up": _B_in["w_up"],
        "B_w_down": _B_in["w_down"],
    }

def reference(A_x, A_wqkv, A_wo, B_x, B_w_gate, B_w_up, B_w_down):
    def _A_ref(x, wqkv, wo):
        B, S, D = x.shape
        H = 32; Dh = D // H
        W, dil = 8, 2
        qkv = (lambda x, *d: x.permute(*d))((x @ wqkv).reshape(B, S, 3, H, Dh), 2, 0, 3, 1, 4)
        q, k, v = qkv[0], qkv[1], qkv[2]
        scale = Dh ** -0.5
        pos = torch.arange(S)
        off = torch.arange(W) * dil
        idx = pos[:, None] - off[None, :]
        mask = idx >= 0
        idx_c = torch.where(mask, idx, 0).reshape(-1)
        kg = k[:, :, idx_c, :].reshape(B, H, S, W, Dh)
        vg = v[:, :, idx_c, :].reshape(B, H, S, W, Dh)
        logits = torch.einsum("bhsd,bhswd->bhsw", q, kg) * scale
        logits = torch.where(mask[None, None, :, :], logits, -1e9)
        attn = _softmax(logits, axis=-1)
        o = torch.einsum("bhsw,bhswd->bhsd", attn, vg)
        return (lambda x, *d: x.permute(*d))(o, 0, 2, 1, 3).reshape(B, S, D) @ wo

    def _B_ref(x, w_gate, w_up, w_down):
        g = torch.einsum("bsd,df->bsf", x, w_gate)
        u = torch.einsum("bsd,df->bsf", x, w_up)
        h = _gelu(g) * u
        return torch.einsum("bsf,fd->bsd", h, w_down)

    x = A_x
    h = x + _A_ref(_layernorm(x, axis=-1), A_wqkv, A_wo)
    h2 = h + _B_ref(_layernorm(h, axis=-1), B_w_gate, B_w_up, B_w_down)
    return h2
```

```asm
; @launch grid=(256,1,1) block=(256,1,1) lds=163840
.amdgcn_target "amdgcn-amd-amdhsa--gfx950"
.text
.globl sequential_preLN__sliding_local_dilated__glu_gated_geglu__prompt_kernel
.p2align 8
.type sequential_preLN__sliding_local_dilated__glu_gated_geglu__prompt_kernel,@function
sequential_preLN__sliding_local_dilated__glu_gated_geglu__prompt_kernel:
    s_load_dwordx16 s[4:19], s[0:1], 0
    s_load_dwordx4 s[20:23], s[0:1], 64
    s_cmp_ge_u32 s2, 256
    s_cbranch_scc1 L_exit
    v_lshrrev_b32 v1, 6, v0
    v_and_b32 v0, 63, v0
    v_readfirstlane_b32 s56, v1
    v_and_b32 v1, 15, v0
    v_lshrrev_b32 v2, 4, v0
    v_lshlrev_b32 v3, 4, v0
    s_getpc_b64 s[60:61]
L_pc:
    s_lshr_b32 s62, s2, 3
    s_lshl_b32 s62, s62, 2
    s_add_u32 s62, s62, s56
    s_lshl_b32 s62, s62, 8
    v_lshl_add_u32 v4, v0, 2, s62
    v_min_u32 v4, L_exit-L_pc, v4
    v_mov_b32 v6, s61
    v_add_co_u32 v4, vcc, s60, v4
    s_nop 1
    v_addc_co_u32 v5, vcc, 0, v6, vcc
    global_load_dword v11, v[4:5], off
    s_and_b32 s60, s2, 7
    s_lshr_b32 s61, s2, 3
    s_lshr_b32 s57, s60, 1
    s_mul_i32 s57, s57, 8
    s_lshr_b32 s62, s61, 2
    s_add_u32 s57, s57, s62
    s_and_b32 s58, s60, 1
    s_mul_i32 s58, s58, 4
    s_and_b32 s62, s61, 3
    s_add_u32 s58, s58, s62
    v_and_b32 v5, 7, v0
    v_xor_b32 v4, v2, v5
    v_lshlrev_b32 v4, 4, v4
    v_xor_b32 v7, 64, v4
    s_lshl_b32 s63, s57, 6
    s_lshl_b32 s64, s56, 4
    s_add_u32 s64, s63, s64
    s_sub_u32 s64, s64, 16
    v_lshrrev_b32 v5, 3, v0
    v_add_u32 v6, s64, v5
    v_max_i32 v26, 0, v6
    v_add_u32 v6, 8, v6
    v_max_i32 v27, 0, v6
    s_movk_i32 s65, 1280
    v_mad_u32_u24 v26, v26, s65, v4
    v_mad_u32_u24 v27, v27, s65, v7
    s_lshl_b32 s64, s56, 3
    s_add_u32 s63, s63, s64
    s_add_u32 s63, s63, 48
    v_add_u32 v6, s63, v5
    s_and_b32 s63, s56, 1
    s_lshl_b32 s63, s63, 6
    v_xor_b32 v4, s63, v4
    v_mad_u32_u24 v28, v6, s65, v4
    s_cmp_lt_u32 s56, 2
    s_cselect_b32 s63, 0, 0x7ff00000
    v_or_b32 v28, s63, v28
    v_cmp_le_u32 vcc, 30, v0
    v_subrev_u32 v5, 30, v0
    v_mov_b32 v7, 3840
    v_cndmask_b32 v5, v0, v5, vcc
    v_cndmask_b32 v6, 0, v7, vcc
    v_mul_u32_u24 v7, 26, v5
    v_lshrrev_b32 v7, 8, v7
    s_movk_i32 s63, 1120
    v_mad_u32_u24 v6, v7, s63, v6
    v_lshl_add_u32 v6, v5, 4, v6
    s_mul_i32 s63, s58, 160
    s_mul_i32 s64, s56, 61440
    s_add_u32 s63, s63, s64
    v_add_u32 v232, s63, v6
    v_add_u32 v233, 6720, v232
    v_add_u32 v234, 30720, v232
    v_add_u32 v235, 37440, v232
    v_add_u32 v236, 15360, v232
    v_add_u32 v237, 22080, v232
    v_add_u32 v238, 46080, v232
    v_add_u32 v239, 52800, v232
    s_lshr_b32 s63, s2, 3
    s_mul_i32 s68, s63, 3
    s_mul_i32 s63, s68, 6554
    s_lshr_b32 s63, s63, 16
    s_mul_i32 s63, s63, 10
    s_sub_u32 s68, s68, s63
    s_lshl_b32 s72, s56, 11
    s_mul_i32 s73, s56, 7680
    s_add_u32 s73, s73, 10240
    s_waitcnt lgkmcnt(0)
    s_mov_b32 s24, s4
    s_and_b32 s25, s5, 0xffff
    s_mov_b32 s26, 2621440
    s_mov_b32 s27, 0x20000
    s_mov_b32 s28, s6
    s_and_b32 s29, s7, 0xffff
    s_mov_b32 s30, 2457600
    s_mov_b32 s31, 0x20000
    s_lshl_b32 s3, s56, 10
    s_add_u32 s3, s3, 8192
    s_cmp_lt_u32 s56, 2
    s_cselect_b32 s3, s3, 163840
    s_mov_b32 s67, 81920
    s_lshl_b32 s69, s68, 7
    s_mul_i32 s70, s68, 245760
    s_add_u32 s0, s73, s67
    s_add_u32 s1, s72, s67
    s_add_u32 s68, s68, 1
    s_cmp_eq_u32 s68, 10
    s_cselect_b32 s68, 0, s68
    s_mov_b32 m0, s1
    s_nop 0
    buffer_load_dwordx4 v26, s[24:27], s69 offen lds
    s_add_u32 m0, s1, 1024
    s_nop 0
    buffer_load_dwordx4 v27, s[24:27], s69 offen lds
    s_add_u32 m0, s3, s67
    s_nop 0
    buffer_load_dwordx4 v28, s[24:27], s69 offen lds
    s_add_u32 m0, s0, 0
    s_mov_b32 exec_hi, 0x0fffffff
    buffer_load_dwordx4 v232, s[28:31], s70 offen lds
    buffer_load_dwordx4 v233, s[28:31], s70 offen offset:960 lds
    s_mov_b32 exec_hi, -1
    s_add_u32 m0, s0, 1920
    s_mov_b32 exec_hi, 0x0fffffff
    buffer_load_dwordx4 v234, s[28:31], s70 offen lds
    buffer_load_dwordx4 v235, s[28:31], s70 offen offset:960 lds
    s_mov_b32 exec_hi, -1
    s_add_u32 m0, s0, 3840
    s_mov_b32 exec_hi, 0x0fffffff
    buffer_load_dwordx4 v236, s[28:31], s70 offen lds
    buffer_load_dwordx4 v237, s[28:31], s70 offen offset:960 lds
    s_mov_b32 exec_hi, -1
    s_add_u32 m0, s0, 5760
    s_mov_b32 exec_hi, 0x0fffffff
    buffer_load_dwordx4 v238, s[28:31], s70 offen lds
    buffer_load_dwordx4 v239, s[28:31], s70 offen offset:960 lds
    s_mov_b32 exec_hi, -1
    v_mov_b32 v60, 0
    s_or_b32 s63, s2, s56
    s_cmp_lg_u32 s63, 0
    s_cbranch_scc1 L_p1_notag
    s_memrealtime s[74:75]
    s_waitcnt lgkmcnt(0)
    s_or_b32 s74, s74, 1
    v_mov_b32 v58, s74
    v_mov_b32 v59, s75
    s_mov_b64 exec, 1
    global_store_dwordx2 v60, v[58:59], s[20:21] sc1
    s_mov_b64 exec, -1
L_p1_notag:
    v_lshrrev_b32 v4, 1, v1
    v_xor_b32 v4, v4, v2
    v_lshlrev_b32 v4, 4, v4
    s_mov_b32 s67, 0
    s_lshl_b32 s69, s68, 7
    s_mul_i32 s70, s68, 245760
    s_add_u32 s0, s73, s67
    s_add_u32 s1, s72, s67
    s_add_u32 s68, s68, 1
    s_cmp_eq_u32 s68, 10
    s_cselect_b32 s68, 0, s68
    v_lshl_add_u32 v29, v1, 7, v4
    v_xor_b32 v30, 64, v29
    s_lshl_b32 s63, s56, 11
    s_add_u32 s63, s63, 2048
    v_add_u32 v37, s63, v29
    v_add_u32 v38, s63, v30
    v_cmp_eq_u32 vcc, 0, v1
    v_mov_b32 v4, 153600
    s_nop 0
    v_cndmask_b32 v34, v29, v4, vcc
    v_cndmask_b32 v35, v30, v4, vcc
    v_cndmask_b32 v36, 1, 0, vcc
    v_lshrrev_b32 v4, 1, v2
    v_lshlrev_b32 v4, 4, v4
    v_and_b32 v5, 1, v2
    v_lshl_add_u32 v4, v5, 2, v4
    v_lshrrev_b32 v5, 2, v1
    v_add_u32 v4, v4, v5
    v_mul_u32_u24 v4, 480, v4
    s_mul_i32 s63, s56, 40
    s_add_u32 s63, s63, 10240
    v_add_u32 v4, s63, v4
    v_and_b32 v5, 3, v0
    s_mov_b32 m0, s1
    s_nop 0
    buffer_load_dwordx4 v26, s[24:27], s69 offen lds
    v_lshl_add_u32 v31, v5, 3, v4
    v_add_u32 v32, 192, v4
    v_add_u32 v6, 32, v4
    v_cmp_eq_u32 vcc, 1, v5
    s_nop 1
    v_cndmask_b32 v32, v32, v6, vcc
    v_add_u32 v6, 352, v4
    v_cmp_eq_u32 vcc, 2, v5
    s_nop 1
    v_cndmask_b32 v32, v32, v6, vcc
    v_mov_b32 v6, 153600
    v_cmp_eq_u32 vcc, 3, v5
    s_nop 1
    v_cndmask_b32 v32, v32, v6, vcc
    v_cndmask_b32 v33, 1, 0, vcc
    s_mov_b32 s63, 0
    v_mad_u32_u24 v240, v33, s63, v32
    s_mov_b32 s63, 3840
    v_mad_u32_u24 v241, v33, s63, v32
    s_mov_b32 s63, 15360
    v_mad_u32_u24 v242, v33, s63, v32
    s_mov_b32 s63, 19200
    v_mad_u32_u24 v243, v33, s63, v32
    v_mov_b32 v4, 0x3f803f80
    v_lshlrev_b32 v5, 2, v1
    s_add_u32 m0, s1, 1024
    s_nop 0
    buffer_load_dwordx4 v27, s[24:27], s69 offen lds
    v_add_u32 v5, 153600, v5
    ds_write_b32 v5, v4
    s_mov_b32 s32, s8
    s_and_b32 s33, s9, 0xffff
    s_mov_b32 s34, 819200
    s_mov_b32 s35, 0x20000
    s_mov_b32 s36, s12
    s_and_b32 s37, s13, 0xffff
    s_mov_b32 s38, 1966080
    s_mov_b32 s39, 0x20000
    s_mov_b32 s40, s14
    s_and_b32 s41, s15, 0xffff
    s_mov_b32 s42, 1966080
    s_mov_b32 s43, 0x20000
    s_mov_b32 s44, s16
    s_and_b32 s45, s17, 0xffff
    s_mov_b32 s46, 1966080
    s_mov_b32 s47, 0x20000
    s_mov_b32 s48, s18
    s_and_b32 s49, s19, 0xffff
    s_mov_b32 s50, 2621440
    s_mov_b32 s51, 0x20000
    s_add_u32 m0, s3, s67
    s_nop 0
    buffer_load_dwordx4 v28, s[24:27], s69 offen lds
    s_mov_b32 s52, s22
    s_and_b32 s53, s23, 0xffff
    s_mov_b32 s54, 19922944
    s_mov_b32 s55, 0x20000
    s_and_b32 s60, s2, 7
    s_lshr_b32 s61, s2, 3
    s_lshr_b32 s6, s60, 0
    s_mul_i32 s6, s6, 4
    s_lshr_b32 s62, s61, 3
    s_add_u32 s6, s6, s62
    s_and_b32 s7, s60, 0
    s_mul_i32 s7, s7, 8
    s_and_b32 s62, s61, 7
    s_add_u32 s7, s7, s62
    s_and_b32 s60, s2, 7
    s_lshr_b32 s61, s2, 3
    s_lshr_b32 s8, s60, 1
    s_mul_i32 s8, s8, 4
    s_lshr_b32 s62, s61, 3
    s_add_u32 s8, s8, s62
    s_and_b32 s9, s60, 1
    s_mul_i32 s9, s9, 8
    s_add_u32 m0, s0, 0
    s_mov_b32 exec_hi, 0x0fffffff
    buffer_load_dwordx4 v232, s[28:31], s70 offen lds
    buffer_load_dwordx4 v233, s[28:31], s70 offen offset:960 lds
    s_mov_b32 exec_hi, -1
    s_and_b32 s62, s61, 7
    s_add_u32 s9, s9, s62
    s_movk_i32 s63, 6554
    s_movk_i32 s64, 1120
    v_add_u32 v4, 0, v0
    v_mul_u32_u24 v5, s63, v4
    v_lshrrev_b32 v5, 16, v5
    v_lshlrev_b32 v4, 4, v4
    v_mad_u32_u24 v46, v5, s64, v4
    v_add_u32 v4, 64, v0
    v_mul_u32_u24 v5, s63, v4
    v_lshrrev_b32 v5, 16, v5
    v_lshlrev_b32 v4, 4, v4
    v_mad_u32_u24 v47, v5, s64, v4
    v_add_u32 v4, 128, v0
    v_mul_u32_u24 v5, s63, v4
    v_lshrrev_b32 v5, 16, v5
    v_lshlrev_b32 v4, 4, v4
    v_mad_u32_u24 v48, v5, s64, v4
    v_add_u32 v4, 192, v0
    v_mul_u32_u24 v5, s63, v4
    v_lshrrev_b32 v5, 16, v5
    s_add_u32 m0, s0, 1920
    s_mov_b32 exec_hi, 0x0fffffff
    buffer_load_dwordx4 v234, s[28:31], s70 offen lds
    buffer_load_dwordx4 v235, s[28:31], s70 offen offset:960 lds
    s_mov_b32 exec_hi, -1
    v_lshlrev_b32 v4, 4, v4
    v_mad_u32_u24 v49, v5, s64, v4
    v_add_u32 v4, 256, v0
    v_mul_u32_u24 v5, s63, v4
    v_lshrrev_b32 v5, 16, v5
    v_lshlrev_b32 v4, 4, v4
    v_mad_u32_u24 v50, v5, s64, v4
    s_mul_i32 s82, s56, 40960
    s_mul_i32 s63, s7, 160
    s_add_u32 s82, s82, s63
    s_mul_i32 s83, s56, 5120
    s_lshl_b32 s71, s2, 1
    s_add_u32 s71, s71, s56
    s_lshr_b32 s63, s2, 3
    s_and_b32 s64, s63, 3
    s_sub_u32 s64, s64, 1
    s_lshr_b32 s63, s63, 2
    s_lshl_b32 s63, s63, 1
    s_add_u32 s63, s63, s64
    s_lshl_b32 s63, s63, 3
    s_and_b32 s74, s2, 7
    s_add_u32 s63, s63, s74
    s_add_u32 m0, s0, 3840
    s_mov_b32 exec_hi, 0x0fffffff
    buffer_load_dwordx4 v236, s[28:31], s70 offen lds
    buffer_load_dwordx4 v237, s[28:31], s70 offen offset:960 lds
    s_mov_b32 exec_hi, -1
    s_add_u32 s63, s63, 512
    s_cmp_lt_u32 s64, 2
    s_cselect_b32 s63, s63, 1000
    s_cmp_lt_u32 s56, 2
    s_cselect_b32 s71, s71, s63
    s_cmp_eq_u32 s56, 3
    s_cselect_b32 s71, 1000, s71
    s_mul_i32 s76, s56, 10240
    s_add_u32 s76, s76, 122880
    s_cmp_ge_u32 s71, 384
    s_cbranch_scc1 L_p1_udown
    s_mul_i32 s77, s71, 1366
    s_lshr_b32 s77, s77, 16
    s_mul_i32 s63, s77, 48
    s_sub_u32 s78, s71, s63
    v_lshrrev_b32 v4, 3, v0
    v_mul_u32_u24 v4, 3072, v4
    v_and_b32 v5, 7, v0
    v_lshl_add_u32 v52, v5, 4, v4
    v_lshl_add_u32 v53, v5, 4, v4
    v_lshl_add_u32 v54, v5, 4, v4
    v_lshl_add_u32 v55, v5, 4, v4
    v_lshl_add_u32 v56, v5, 4, v4
    s_mul_i32 s79, s77, 245760
    s_lshr_b32 s64, s78, 1
    s_lshl_b32 s64, s64, 7
    s_add_u32 s79, s79, s64
    s_add_u32 s80, s79, 122880
    s_mov_b32 s81, 24576
    s_cmp_eq_u32 s56, 0
    s_cselect_b64 s[12:13], s[36:37], s[40:41]
    s_cselect_b64 s[16:17], s[36:37], s[40:41]
    v_bfe_u32 v4, v0, 1, 1
    v_mul_u32_u24 v4, 10240, v4
    v_and_b32 v5, 1, v0
    v_lshl_add_u32 v4, v5, 3, v4
    v_and_b32 v5, 1, v2
    v_lshl_add_u32 v4, v5, 4, v4
    v_lshrrev_b32 v5, 2, v1
    v_lshl_add_u32 v4, v5, 7, v4
    s_lshl_b32 s63, s56, 6
    s_add_u32 s63, s63, 122880
    v_add_u32 v4, s63, v4
    v_lshrrev_b32 v5, 5, v0
    v_lshl_add_u32 v252, v5, 10, v4
    v_mul_u32_u24 v5, 5120, v5
    v_add_u32 v253, v5, v4
    s_mul_i32 s74, s78, 21846
    s_lshr_b32 s74, s74, 16
    s_mul_i32 s64, s74, 3
    s_sub_u32 s75, s78, s64
    s_lshl_b32 s75, s75, 1
    s_mul_i32 s74, s74, 240
    s_lshr_b32 s65, s77, 1
    s_mul_i32 s65, s65, 10
    s_and_b32 s63, s77, 1
    s_add_u32 s59, s65, s63
    s_add_u32 s59, s59, 8
    s_lshl_b32 s63, s63, 2
    s_add_u32 s65, s65, s63
    s_mul_i32 s63, s75, 40
    s_cmp_lt_u32 s75, 3
    s_cselect_b32 s63, s75, s63
    s_cselect_b32 s38, 3, 1
    s_add_u32 s63, s63, s74
    s_mul_i32 s36, s65, s38
    s_add_u32 s36, s36, s63
    s_lshl_b32 s36, s36, 10
    s_mul_i32 s37, s59, s38
    s_add_u32 s37, s37, s63
    s_lshl_b32 s37, s37, 10
    s_lshl_b32 s38, s38, 10
    s_add_u32 s75, s75, 1
    s_mul_i32 s63, s75, 40
    s_cmp_lt_u32 s75, 3
    s_cselect_b32 s63, s75, s63
    s_cselect_b32 s41, 3, 1
    s_add_u32 s63, s63, s74
    s_mul_i32 s39, s65, s41
    s_add_u32 s39, s39, s63
    s_lshl_b32 s39, s39, 10
    s_mul_i32 s40, s59, s41
    s_add_u32 s40, s40, s63
    s_lshl_b32 s40, s40, 10
    s_lshl_b32 s41, s41, 10
    s_mul_i32 s63, s77, 12288
    s_lshl_b32 s64, s78, 8
    s_add_u32 s63, s63, s64
    s_add_u32 s42, s63, 5898240
    s_branch L_p1_uset
L_p1_udown:
    s_sub_u32 s63, s71, 384
    s_lshr_b32 s77, s63, 3
    s_and_b32 s78, s63, 7
    s_mul_i32 s74, s77, 43
    s_lshr_b32 s74, s74, 8
    s_mul_i32 s63, s74, 6
    s_sub_u32 s75, s77, s63
    s_mul_i32 s79, s75, 96
    s_lshl_b32 s63, s75, 4
    s_lshl_b32 s64, s75, 1
    s_cmp_lt_u32 s75, 4
    s_cselect_b32 s79, s79, s63
    s_cselect_b32 s75, s75, s64
    s_cselect_b32 s65, 0, 102400
    s_cselect_b32 s37, 20, 5
    s_movk_i32 s63, 192
    s_cselect_b32 s80, 32, s63
    s_mul_i32 s63, s74, 384
    s_add_u32 s79, s79, s63
    s_mul_i32 s79, s79, 1280
    s_mul_i32 s64, s78, 160
    s_add_u32 s79, s79, s64
    s_mul_i32 s80, s80, 1280
    s_add_u32 s80, s80, s79
    v_mov_b32 v5, s65
    v_cmp_le_u32 vcc, 20480, v46
    s_nop 1
    v_cndmask_b32 v4, 0, v5, vcc
    v_add_u32 v52, v4, v46
    v_cmp_le_u32 vcc, 20480, v47
    s_nop 1
    v_cndmask_b32 v4, 0, v5, vcc
    v_add_u32 v53, v4, v47
    v_cmp_le_u32 vcc, 20480, v48
    s_nop 1
    v_cndmask_b32 v4, 0, v5, vcc
    v_add_u32 v54, v4, v48
    v_cmp_le_u32 vcc, 20480, v49
    s_nop 1
    v_cndmask_b32 v4, 0, v5, vcc
    v_add_u32 v55, v4, v49
    v_cmp_le_u32 vcc, 20480, v50
    s_nop 1
    v_cndmask_b32 v4, 0, v5, vcc
    v_add_u32 v56, v4, v50
    s_mov_b32 s81, 0
    s_mov_b64 s[12:13], s[44:45]
    s_mov_b64 s[16:17], s[44:45]
    v_lshrrev_b32 v4, 1, v2
    v_lshlrev_b32 v4, 4, v4
    v_and_b32 v5, 1, v2
    v_lshl_add_u32 v4, v5, 2, v4
    v_lshrrev_b32 v5, 2, v1
    v_add_u32 v4, v4, v5
    v_mul_u32_u24 v4, 160, v4
    v_and_b32 v5, 3, v0
    v_mul_u32_u24 v5, 40, v5
    v_add3_u32 v252, v4, v5, s76
    s_mul_i32 s63, s78, 240
    s_mul_i32 s64, s74, 60
    s_add_u32 s63, s63, s64
    s_mul_i32 s64, s75, 5
    s_add_u32 s63, s63, s64
    s_add_u32 s37, s37, s63
    s_lshl_b32 s63, s63, 10
    s_add_u32 s36, s63, 3932160
    s_lshl_b32 s37, s37, 10
    s_add_u32 s37, s37, 3932160
L_p1_uset:
    s_cmp_lt_u32 s71, 576
    s_cselect_b32 s14, 1966080, 0
    s_cselect_b32 s18, 1966080, 0
    s_cselect_b32 s76, s76, 0x30000
    s_mov_b32 s15, 0x20000
    s_mov_b32 s19, 0x20000
    v_mov_b32 v64, 0
    v_mov_b32 v65, 0
    v_mov_b32 v66, 0
    v_mov_b32 v67, 0
    v_mov_b32 v68, 0
    v_mov_b32 v69, 0
    v_mov_b32 v70, 0
    v_mov_b32 v71, 0
    v_mov_b32 v72, 0
    v_mov_b32 v73, 0
    v_mov_b32 v74, 0
    v_mov_b32 v75, 0
    v_mov_b32 v76, 0
    v_mov_b32 v77, 0
    v_mov_b32 v78, 0
    v_mov_b32 v79, 0
    v_mov_b32 v80, 0
    v_mov_b32 v81, 0
    v_mov_b32 v82, 0
    v_mov_b32 v83, 0
    s_add_u32 m0, s0, 5760
    s_mov_b32 exec_hi, 0x0fffffff
    buffer_load_dwordx4 v238, s[28:31], s70 offen lds
    buffer_load_dwordx4 v239, s[28:31], s70 offen offset:960 lds
    s_mov_b32 exec_hi, -1
    v_mov_b32 v84, 0
    v_mov_b32 v85, 0
    v_mov_b32 v86, 0
    v_mov_b32 v87, 0
    v_mov_b32 v88, 0
    v_mov_b32 v89, 0
    v_mov_b32 v90, 0
    v_mov_b32 v91, 0
    v_mov_b32 v92, 0
    v_mov_b32 v93, 0
    v_mov_b32 v94, 0
    v_mov_b32 v95, 0
    v_mov_b32 v96, 0
    v_mov_b32 v97, 0
    v_mov_b32 v98, 0
    v_mov_b32 v99, 0
    v_mov_b32 v100, 0
    v_mov_b32 v101, 0
    v_mov_b32 v102, 0
    v_mov_b32 v103, 0
    v_mov_b32 v104, 0
    v_mov_b32 v105, 0
    s_mov_b32 s67, 40960
    s_lshl_b32 s69, s68, 7
    s_mul_i32 s70, s68, 245760
    s_add_u32 s0, s73, s67
    s_add_u32 s1, s72, s67
    s_add_u32 s68, s68, 1
    s_cmp_eq_u32 s68, 10
    s_cselect_b32 s68, 0, s68
    v_mov_b32 v106, 0
    v_mov_b32 v107, 0
    v_mov_b32 v108, 0
    v_mov_b32 v109, 0
    v_mov_b32 v110, 0
    v_mov_b32 v111, 0
    v_mov_b32 v112, 0
    v_mov_b32 v113, 0
    v_mov_b32 v114, 0
    v_mov_b32 v115, 0
    v_mov_b32 v116, 0
    v_mov_b32 v117, 0
    v_mov_b32 v118, 0
    v_mov_b32 v119, 0
    v_mov_b32 v120, 0
    v_mov_b32 v121, 0
    v_mov_b32 v122, 0
    v_mov_b32 v123, 0
    v_mov_b32 v124, 0
    v_mov_b32 v125, 0
    v_mov_b32 v126, 0
    v_mov_b32 v127, 0
    s_mov_b32 m0, s1
    s_nop 0
    buffer_load_dwordx4 v26, s[24:27], s69 offen lds
    v_mov_b32 v128, 0
    v_mov_b32 v129, 0
    v_mov_b32 v130, 0
    v_mov_b32 v131, 0
    v_mov_b32 v132, 0
    v_mov_b32 v133, 0
    v_mov_b32 v134, 0
    v_mov_b32 v135, 0
    v_mov_b32 v136, 0
    v_mov_b32 v137, 0
    v_mov_b32 v138, 0
    v_mov_b32 v139, 0
    v_mov_b32 v140, 0
    v_mov_b32 v141, 0
    v_mov_b32 v142, 0
    v_mov_b32 v143, 0
    v_mov_b32 v144, 0
    v_mov_b32 v145, 0
    v_mov_b32 v146, 0
    v_mov_b32 v147, 0
    v_mov_b32 v148, 0
    v_mov_b32 v149, 0
    s_add_u32 m0, s1, 1024
    s_nop 0
    buffer_load_dwordx4 v27, s[24:27], s69 offen lds
    v_mov_b32 v150, 0
    v_mov_b32 v151, 0
    v_lshlrev_b32 v4, 2, v2
    v_sub_u32 v4, v1, v4
    v_and_b32 v4, -2, v4
    v_mov_b32 v6, 0xf149f2ca
    s_cmp_eq_u32 s57, 0
    s_cselect_b32 s63, 0xceabfb8f, 0
    s_cselect_b32 s59, 0, 0x3ea52b5c
    v_mov_b32 v7, s63
    v_add_u32 v5, 16, v4
    v_cmp_gt_u32 vcc, 16, v5
    s_nop 1
    v_cndmask_b32 v16, v6, 0, vcc
    v_cndmask_b32 v20, v6, v7, vcc
    v_add_u32 v5, 14, v4
    v_cmp_gt_u32 vcc, 16, v5
    s_nop 1
    v_cndmask_b32 v17, v6, 0, vcc
    v_cndmask_b32 v21, v6, v7, vcc
    v_add_u32 v5, 0, v4
    v_cmp_gt_u32 vcc, 16, v5
    s_nop 1
    v_cndmask_b32 v18, v6, 0, vcc
    v_add_u32 v5, -2, v4
    v_cmp_gt_u32 vcc, 16, v5
    s_nop 1
    v_cndmask_b32 v19, v6, 0, vcc
    s_add_u32 m0, s3, s67
    s_nop 0
    buffer_load_dwordx4 v28, s[24:27], s69 offen lds
    v_and_b32 v4, 1, v2
    v_mul_u32_u24 v4, 20480, v4
    v_lshrrev_b32 v5, 1, v2
    v_lshl_add_u32 v4, v5, 8, v4
    v_lshl_add_u32 v22, v1, 4, v4
    v_mul_u32_u24 v5, 20480, v2
    v_lshl_add_u32 v23, v1, 3, v5
    s_mul_i32 s63, s56, 3328
    s_add_u32 s63, s63, 102400
    v_mul_u32_u24 v4, 40, v1
    v_add_u32 v25, s63, v4
    v_lshl_add_u32 v24, v2, 3, v25
    v_lshrrev_b32 v5, 2, v0
    v_mul_u32_u24 v5, 40, v5
    v_add_u32 v15, s63, v5
    v_and_b32 v5, 3, v0
    v_lshl_add_u32 v14, v5, 3, v15
    s_lshr_b32 s63, s58, 1
    s_mul_i32 s63, s63, 20
    s_mul_i32 s64, s57, 320
    s_add_u32 s63, s63, s64
    s_and_b32 s64, s58, 1
    s_add_u32 m0, s0, 0
    s_mov_b32 exec_hi, 0x0fffffff
    buffer_load_dwordx4 v232, s[28:31], s70 offen lds
    buffer_load_dwordx4 v233, s[28:31], s70 offen offset:960 lds
    s_mov_b32 exec_hi, -1
    s_lshl_b32 s22, s64, 3
    s_add_u32 s22, s22, s63
    s_lshl_b32 s23, s56, 1
    s_add_u32 s22, s22, s23
    s_lshl_b32 s22, s22, 8
    s_add_u32 s22, s22, 6291456
    s_lshl_b32 s64, s64, 1
    s_add_u32 s63, s63, s64
    s_lshr_b32 s64, s56, 1
    s_add_u32 s63, s63, s64
    s_lshl_b32 s63, s63, 8
    s_and_b32 s64, s56, 1
    s_lshl_b32 s64, s64, 7
    s_add_u32 s63, s63, s64
    s_add_u32 s23, s63, 6295552
    s_mov_b32 s65, 0
    s_mov_b32 s66, 81920
    s_lshl_b32 s63, s2, 2
    s_add_u32 s63, s63, s56
    s_lshl_b32 s63, s63, 10
    buffer_load_dword v11, v3, s[32:35], s63 offen
    s_waitcnt vmcnt(17) lgkmcnt(0)
    v_add_u32 v41, s66, v31
    v_add_u32 v39, s66, v29
    v_add_u32 v40, s66, v30
    s_barrier
    ds_read_b64_tr_b16 v[200:201], v41 offset:0
    v_mad_u32_u24 v44, v33, s66, v240
    ds_read_b64_tr_b16 v[202:203], v41 offset:3840
    v_mad_u32_u24 v45, v33, s66, v241
    ds_read_b64_tr_b16 v[204:205], v41 offset:160
    ds_read_b64_tr_b16 v[206:207], v41 offset:4000
    v_mad_u32_u24 v42, v36, s66, v34
    ds_read_b64_tr_b16 v[208:209], v41 offset:320
    ds_read_b64_tr_b16 v[210:211], v41 offset:4160
    v_add_u32 v43, s66, v37
    ds_read_b64_tr_b16 v[212:213], v44
    ds_read_b64_tr_b16 v[214:215], v45
    ds_read_b128 v[152:155], v42
    ds_read_b128 v[156:159], v39 offset:2048
    ds_read_b128 v[160:163], v39 offset:4096
    ds_read_b128 v[164:167], v39 offset:6144
    ds_read_b128 v[168:171], v39 offset:8192
    ds_read_b128 v[172:175], v43
L_p1_loop:
    s_waitcnt lgkmcnt(0)
    v_mfma_f32_16x16x32_bf16 v[72:75], v[200:203], v[152:155], v[72:75]
    ds_read_b64_tr_b16 v[216:217], v41 offset:15360
    v_mad_u32_u24 v44, v33, s66, v242
    v_mfma_f32_16x16x32_bf16 v[76:79], v[204:207], v[152:155], v[76:79]
    ds_read_b64_tr_b16 v[218:219], v41 offset:19200
    v_mad_u32_u24 v45, v33, s66, v243
    v_mfma_f32_16x16x32_bf16 v[80:83], v[208:211], v[152:155], v[80:83]
    ds_read_b64_tr_b16 v[220:221], v41 offset:15520
    s_add_u32 m0, s0, 1920
    v_mfma_f32_16x16x32_bf16 v[84:87], v[212:215], v[152:155], v[84:87]
    s_mov_b32 exec_hi, 0x0fffffff
    buffer_load_dwordx4 v234, s[28:31], s70 offen lds
    buffer_load_dwordx4 v235, s[28:31], s70 offen offset:960 lds
    s_mov_b32 exec_hi, -1
    v_mfma_f32_16x16x32_bf16 v[88:91], v[200:203], v[156:159], v[88:91]
    ds_read_b64_tr_b16 v[222:223], v41 offset:19360
    v_mad_u32_u24 v42, v36, s66, v35
    v_mfma_f32_16x16x32_bf16 v[92:95], v[204:207], v[156:159], v[92:95]
    ds_read_b64_tr_b16 v[224:225], v41 offset:15680
    v_mfma_f32_16x16x32_bf16 v[96:99], v[208:211], v[156:159], v[96:99]
    ds_read_b64_tr_b16 v[226:227], v41 offset:19520
    v_add_u32 v43, s66, v38
    v_mfma_f32_16x16x32_bf16 v[100:103], v[212:215], v[156:159], v[100:103]
    ds_read_b64_tr_b16 v[228:229], v44
    v_mfma_f32_16x16x32_bf16 v[104:107], v[200:203], v[160:163], v[104:107]
    ds_read_b64_tr_b16 v[230:231], v45
    s_add_u32 m0, s0, 3840
    v_mfma_f32_16x16x32_bf16 v[108:111], v[204:207], v[160:163], v[108:111]
    s_mov_b32 exec_hi, 0x0fffffff
    buffer_load_dwordx4 v236, s[28:31], s70 offen lds
    buffer_load_dwordx4 v237, s[28:31], s70 offen offset:960 lds
    s_mov_b32 exec_hi, -1
    v_mfma_f32_16x16x32_bf16 v[112:115], v[208:211], v[160:163], v[112:115]
    ds_read_b128 v[176:179], v42
    v_mfma_f32_16x16x32_bf16 v[116:119], v[212:215], v[160:163], v[116:119]
    ds_read_b128 v[180:183], v40 offset:2048
    v_mfma_f32_16x16x32_bf16 v[120:123], v[200:203], v[164:167], v[120:123]
    ds_read_b128 v[184:187], v40 offset:4096
    s_add_u32 m0, s0, 5760
    v_mfma_f32_16x16x32_bf16 v[124:127], v[204:207], v[164:167], v[124:127]
    s_mov_b32 exec_hi, 0x0fffffff
    buffer_load_dwordx4 v238, s[28:31], s70 offen lds
    buffer_load_dwordx4 v239, s[28:31], s70 offen offset:960 lds
    s_mov_b32 exec_hi, -1
    v_mfma_f32_16x16x32_bf16 v[128:131], v[208:211], v[164:167], v[128:131]
    ds_read_b128 v[188:191], v40 offset:6144
    v_mfma_f32_16x16x32_bf16 v[132:135], v[212:215], v[164:167], v[132:135]
    ds_read_b128 v[192:195], v40 offset:8192
    v_mfma_f32_16x16x32_bf16 v[136:139], v[200:203], v[168:171], v[136:139]
    ds_read_b128 v[196:199], v43
    v_mfma_f32_16x16x32_bf16 v[140:143], v[204:207], v[168:171], v[140:143]
    s_mov_b32 s67, s66
    s_add_u32 s66, s66, 40960
    s_cmp_eq_u32 s66, 122880
    v_mfma_f32_16x16x32_bf16 v[144:147], v[208:211], v[168:171], v[144:147]
    s_cselect_b32 s66, 0, s66
    s_lshl_b32 s69, s68, 7
    s_mul_i32 s70, s68, 245760
    v_mfma_f32_16x16x32_bf16 v[148:151], v[212:215], v[168:171], v[148:151]
    s_add_u32 s0, s73, s67
    s_add_u32 s1, s72, s67
    s_add_u32 s68, s68, 1
    v_mfma_f32_16x16x32_bf16 v[64:67], v[152:155], v[152:155], v[64:67]
    s_cmp_eq_u32 s68, 10
    s_cselect_b32 s68, 0, s68
    v_add_u32 v41, s66, v31
    v_mfma_f32_16x16x32_bf16 v[68:71], v[172:175], v[172:175], v[68:71]
    v_add_u32 v39, s66, v29
    v_add_u32 v40, s66, v30
    s_waitcnt vmcnt(11) lgkmcnt(0)
    s_barrier
    v_mfma_f32_16x16x32_bf16 v[72:75], v[216:219], v[176:179], v[72:75]
    ds_read_b64_tr_b16 v[200:201], v41 offset:0
    v_mad_u32_u24 v44, v33, s66, v240
    v_mfma_f32_16x16x32_bf16 v[76:79], v[220:223], v[176:179], v[76:79]
    ds_read_b64_tr_b16 v[202:203], v41 offset:3840
    v_mad_u32_u24 v45, v33, s66, v241
    v_mfma_f32_16x16x32_bf16 v[80:83], v[224:227], v[176:179], v[80:83]
    ds_read_b64_tr_b16 v[204:205], v41 offset:160
    s_mov_b32 m0, s1
    v_mfma_f32_16x16x32_bf16 v[84:87], v[228:231], v[176:179], v[84:87]
    buffer_load_dwordx4 v26, s[24:27], s69 offen lds
    v_mfma_f32_16x16x32_bf16 v[88:91], v[216:219], v[180:183], v[88:91]
    ds_read_b64_tr_b16 v[206:207], v41 offset:4000
    v_mad_u32_u24 v42, v36, s66, v34
    v_mfma_f32_16x16x32_bf16 v[92:95], v[220:223], v[180:183], v[92:95]
    ds_read_b64_tr_b16 v[208:209], v41 offset:320
    v_mfma_f32_16x16x32_bf16 v[96:99], v[224:227], v[180:183], v[96:99]
    ds_read_b64_tr_b16 v[210:211], v41 offset:4160
    v_add_u32 v43, s66, v37
    v_mfma_f32_16x16x32_bf16 v[100:103], v[228:231], v[180:183], v[100:103]
    ds_read_b64_tr_b16 v[212:213], v44
    s_add_u32 m0, s1, 1024
    v_mfma_f32_16x16x32_bf16 v[104:107], v[216:219], v[184:187], v[104:107]
    buffer_load_dwordx4 v27, s[24:27], s69 offen lds
    v_mfma_f32_16x16x32_bf16 v[108:111], v[220:223], v[184:187], v[108:111]
    ds_read_b64_tr_b16 v[214:215], v45
    v_mfma_f32_16x16x32_bf16 v[112:115], v[224:227], v[184:187], v[112:115]
    ds_read_b128 v[152:155], v42
    s_add_u32 m0, s3, s67
    v_mfma_f32_16x16x32_bf16 v[116:119], v[228:231], v[184:187], v[116:119]
    buffer_load_dwordx4 v28, s[24:27], s69 offen lds
    v_mfma_f32_16x16x32_bf16 v[120:123], v[216:219], v[188:191], v[120:123]
    ds_read_b128 v[156:159], v39 offset:2048
    v_mfma_f32_16x16x32_bf16 v[124:127], v[220:223], v[188:191], v[124:127]
    ds_read_b128 v[160:163], v39 offset:4096
    s_add_u32 m0, s0, 0
    v_mfma_f32_16x16x32_bf16 v[128:131], v[224:227], v[188:191], v[128:131]
    s_mov_b32 exec_hi, 0x0fffffff
    buffer_load_dwordx4 v232, s[28:31], s70 offen lds
    buffer_load_dwordx4 v233, s[28:31], s70 offen offset:960 lds
    s_mov_b32 exec_hi, -1
    v_mfma_f32_16x16x32_bf16 v[132:135], v[228:231], v[188:191], v[132:135]
    ds_read_b128 v[164:167], v39 offset:6144
    v_mfma_f32_16x16x32_bf16 v[136:139], v[216:219], v[192:195], v[136:139]
    ds_read_b128 v[168:171], v39 offset:8192
    v_mfma_f32_16x16x32_bf16 v[140:143], v[220:223], v[192:195], v[140:143]
    ds_read_b128 v[172:175], v43
    v_mfma_f32_16x16x32_bf16 v[144:147], v[224:227], v[192:195], v[144:147]
    v_mfma_f32_16x16x32_bf16 v[148:151], v[228:231], v[192:195], v[148:151]
    v_mfma_f32_16x16x32_bf16 v[64:67], v[176:179], v[176:179], v[64:67]
    v_mfma_f32_16x16x32_bf16 v[68:71], v[196:199], v[196:199], v[68:71]
    s_add_u32 s65, s65, 1
    s_cmp_lt_u32 s65, 7
    s_cbranch_scc1 L_p1_loop
    s_waitcnt lgkmcnt(0)
    v_mfma_f32_16x16x32_bf16 v[72:75], v[200:203], v[152:155], v[72:75]
    ds_read_b64_tr_b16 v[216:217], v41 offset:15360
    v_mad_u32_u24 v44, v33, s66, v242
    v_mfma_f32_16x16x32_bf16 v[76:79], v[204:207], v[152:155], v[76:79]
    ds_read_b64_tr_b16 v[218:219], v41 offset:19200
    v_mad_u32_u24 v45, v33, s66, v243
    v_mfma_f32_16x16x32_bf16 v[80:83], v[208:211], v[152:155], v[80:83]
    ds_read_b64_tr_b16 v[220:221], v41 offset:15520
    v_mfma_f32_16x16x32_bf16 v[84:87], v[212:215], v[152:155], v[84:87]
    global_load_dwordx2 v[58:59], v60, s[20:21] sc1
    v_mfma_f32_16x16x32_bf16 v[88:91], v[200:203], v[156:159], v[88:91]
    ds_read_b64_tr_b16 v[222:223], v41 offset:19360
    v_mad_u32_u24 v42, v36, s66, v35
    v_mfma_f32_16x16x32_bf16 v[92:95], v[204:207], v[156:159], v[92:95]
    ds_read_b64_tr_b16 v[224:225], v41 offset:15680
    v_mfma_f32_16x16x32_bf16 v[96:99], v[208:211], v[156:159], v[96:99]
    ds_read_b64_tr_b16 v[226:227], v41 offset:19520
    v_add_u32 v43, s66, v38
    v_mfma_f32_16x16x32_bf16 v[100:103], v[212:215], v[156:159], v[100:103]
    ds_read_b64_tr_b16 v[228:229], v44
    s_add_u32 m0, s0, 1920
    v_mfma_f32_16x16x32_bf16 v[104:107], v[200:203], v[160:163], v[104:107]
    s_mov_b32 exec_hi, 0x0fffffff
    buffer_load_dwordx4 v234, s[28:31], s70 offen lds
    buffer_load_dwordx4 v235, s[28:31], s70 offen offset:960 lds
    s_mov_b32 exec_hi, -1
    v_mfma_f32_16x16x32_bf16 v[108:111], v[204:207], v[160:163], v[108:111]
    ds_read_b64_tr_b16 v[230:231], v45
    v_mfma_f32_16x16x32_bf16 v[112:115], v[208:211], v[160:163], v[112:115]
    ds_read_b128 v[176:179], v42
    s_add_u32 m0, s0, 3840
    v_mfma_f32_16x16x32_bf16 v[116:119], v[212:215], v[160:163], v[116:119]
    s_mov_b32 exec_hi, 0x0fffffff
    buffer_load_dwordx4 v236, s[28:31], s70 offen lds
    buffer_load_dwordx4 v237, s[28:31], s70 offen offset:960 lds
    s_mov_b32 exec_hi, -1
    v_mfma_f32_16x16x32_bf16 v[120:123], v[200:203], v[164:167], v[120:123]
    ds_read_b128 v[180:183], v40 offset:2048
    v_mfma_f32_16x16x32_bf16 v[124:127], v[204:207], v[164:167], v[124:127]
    ds_read_b128 v[184:187], v40 offset:4096
    s_add_u32 m0, s0, 5760
    v_mfma_f32_16x16x32_bf16 v[128:131], v[208:211], v[164:167], v[128:131]
    s_mov_b32 exec_hi, 0x0fffffff
    buffer_load_dwordx4 v238, s[28:31], s70 offen lds
    buffer_load_dwordx4 v239, s[28:31], s70 offen offset:960 lds
    s_mov_b32 exec_hi, -1
    v_mfma_f32_16x16x32_bf16 v[132:135], v[212:215], v[164:167], v[132:135]
    ds_read_b128 v[188:191], v40 offset:6144
    v_mfma_f32_16x16x32_bf16 v[136:139], v[200:203], v[168:171], v[136:139]
    ds_read_b128 v[192:195], v40 offset:8192
    v_mfma_f32_16x16x32_bf16 v[140:143], v[204:207], v[168:171], v[140:143]
    ds_read_b128 v[196:199], v43
    v_mfma_f32_16x16x32_bf16 v[144:147], v[208:211], v[168:171], v[144:147]
    s_mov_b32 s67, s66
    s_add_u32 s66, s66, 40960
    s_cmp_eq_u32 s66, 122880
    v_mfma_f32_16x16x32_bf16 v[148:151], v[212:215], v[168:171], v[148:151]
    s_cselect_b32 s66, 0, s66
    v_add_u32 v41, s66, v31
    v_add_u32 v39, s66, v29
    v_mfma_f32_16x16x32_bf16 v[64:67], v[152:155], v[152:155], v[64:67]
    v_add_u32 v40, s66, v30
    v_mfma_f32_16x16x32_bf16 v[68:71], v[172:175], v[172:175], v[68:71]
    s_waitcnt vmcnt(11) lgkmcnt(0)
    s_barrier
    v_mfma_f32_16x16x32_bf16 v[72:75], v[216:219], v[176:179], v[72:75]
    ds_read_b64_tr_b16 v[200:201], v41 offset:0
    v_mad_u32_u24 v44, v33, s66, v240
    ds_read_b64_tr_b16 v[202:203], v41 offset:3840
    v_mad_u32_u24 v45, v33, s66, v241
    v_mfma_f32_16x16x32_bf16 v[76:79], v[220:223], v[176:179], v[76:79]
    ds_read_b64_tr_b16 v[204:205], v41 offset:160
    s_add_u32 m0, s76, 0
    v_mfma_f32_16x16x32_bf16 v[80:83], v[224:227], v[176:179], v[80:83]
    buffer_load_dwordx4 v52, s[12:15], s79 offen lds
    s_add_u32 s79, s79, s81
    v_mfma_f32_16x16x32_bf16 v[84:87], v[228:231], v[176:179], v[84:87]
    ds_read_b64_tr_b16 v[206:207], v41 offset:4000
    v_mad_u32_u24 v42, v36, s66, v34
    v_mfma_f32_16x16x32_bf16 v[88:91], v[216:219], v[180:183], v[88:91]
    ds_read_b64_tr_b16 v[208:209], v41 offset:320
    s_add_u32 m0, s76, 5120
    v_mfma_f32_16x16x32_bf16 v[92:95], v[220:223], v[180:183], v[92:95]
    buffer_load_dwordx4 v52, s[16:19], s80 offen lds
    s_add_u32 s80, s80, s81
    v_mfma_f32_16x16x32_bf16 v[96:99], v[224:227], v[180:183], v[96:99]
    ds_read_b64_tr_b16 v[210:211], v41 offset:4160
    v_add_u32 v43, s66, v37
    v_mfma_f32_16x16x32_bf16 v[100:103], v[228:231], v[180:183], v[100:103]
    ds_read_b64_tr_b16 v[212:213], v44
    s_add_u32 m0, s76, 1024
    v_mfma_f32_16x16x32_bf16 v[104:107], v[216:219], v[184:187], v[104:107]
    buffer_load_dwordx4 v53, s[12:15], s79 offen lds
    s_add_u32 s79, s79, s81
    v_mfma_f32_16x16x32_bf16 v[108:111], v[220:223], v[184:187], v[108:111]
    ds_read_b64_tr_b16 v[214:215], v45
    s_add_u32 m0, s76, 6144
    v_mfma_f32_16x16x32_bf16 v[112:115], v[224:227], v[184:187], v[112:115]
    buffer_load_dwordx4 v53, s[16:19], s80 offen lds
    s_add_u32 s80, s80, s81
    v_mfma_f32_16x16x32_bf16 v[116:119], v[228:231], v[184:187], v[116:119]
    ds_read_b128 v[152:155], v42
    s_add_u32 m0, s76, 2048
    s_nop 0
    buffer_load_dwordx4 v54, s[12:15], s79 offen lds
    s_add_u32 s79, s79, s81
    v_mfma_f32_16x16x32_bf16 v[120:123], v[216:219], v[188:191], v[120:123]
    ds_read_b128 v[156:159], v39 offset:2048
    s_add_u32 m0, s76, 7168
    v_mfma_f32_16x16x32_bf16 v[124:127], v[220:223], v[188:191], v[124:127]
    buffer_load_dwordx4 v54, s[16:19], s80 offen lds
    s_add_u32 s80, s80, s81
    v_mfma_f32_16x16x32_bf16 v[128:131], v[224:227], v[188:191], v[128:131]
    ds_read_b128 v[160:163], v39 offset:4096
    s_add_u32 m0, s76, 3072
    v_mfma_f32_16x16x32_bf16 v[132:135], v[228:231], v[188:191], v[132:135]
    buffer_load_dwordx4 v55, s[12:15], s79 offen lds
    s_add_u32 s79, s79, s81
    v_mfma_f32_16x16x32_bf16 v[136:139], v[216:219], v[192:195], v[136:139]
    ds_read_b128 v[164:167], v39 offset:6144
    s_add_u32 m0, s76, 8192
    v_mfma_f32_16x16x32_bf16 v[140:143], v[220:223], v[192:195], v[140:143]
    buffer_load_dwordx4 v55, s[16:19], s80 offen lds
    s_add_u32 s80, s80, s81
    v_mfma_f32_16x16x32_bf16 v[144:147], v[224:227], v[192:195], v[144:147]
    ds_read_b128 v[168:171], v39 offset:8192
    s_add_u32 m0, s76, 4096
    v_mfma_f32_16x16x32_bf16 v[148:151], v[228:231], v[192:195], v[148:151]
    buffer_load_dwordx4 v56, s[12:15], s79 offen lds
    s_add_u32 s79, s79, s81
    v_mfma_f32_16x16x32_bf16 v[64:67], v[176:179], v[176:179], v[64:67]
    ds_read_b128 v[172:175], v43
    s_add_u32 m0, s76, 9216
    v_mfma_f32_16x16x32_bf16 v[68:71], v[196:199], v[196:199], v[68:71]
    buffer_load_dwordx4 v56, s[16:19], s80 offen lds
    s_add_u32 s80, s80, s81
    s_waitcnt lgkmcnt(0)
    v_mfma_f32_16x16x32_bf16 v[72:75], v[200:203], v[152:155], v[72:75]
    ds_read_b64_tr_b16 v[216:217], v41 offset:15360
    v_mad_u32_u24 v44, v33, s66, v242
    v_mfma_f32_16x16x32_bf16 v[76:79], v[204:207], v[152:155], v[76:79]
    ds_read_b64_tr_b16 v[218:219], v41 offset:19200
    v_mad_u32_u24 v45, v33, s66, v243
    v_mfma_f32_16x16x32_bf16 v[80:83], v[208:211], v[152:155], v[80:83]
    ds_read_b64_tr_b16 v[220:221], v41 offset:15520
    s_add_u32 m0, s83, 0
    s_add_u32 s69, s82, 0
    v_mfma_f32_16x16x32_bf16 v[84:87], v[212:215], v[152:155], v[84:87]
    buffer_load_dwordx4 v46, s[32:35], s69 offen lds
    v_mfma_f32_16x16x32_bf16 v[88:91], v[200:203], v[156:159], v[88:91]
    ds_read_b64_tr_b16 v[222:223], v41 offset:19360
    v_mad_u32_u24 v42, v36, s66, v35
    v_mfma_f32_16x16x32_bf16 v[92:95], v[204:207], v[156:159], v[92:95]
    ds_read_b64_tr_b16 v[224:225], v41 offset:15680
    v_mfma_f32_16x16x32_bf16 v[96:99], v[208:211], v[156:159], v[96:99]
    ds_read_b64_tr_b16 v[226:227], v41 offset:19520
    v_add_u32 v43, s66, v38
    v_mfma_f32_16x16x32_bf16 v[100:103], v[212:215], v[156:159], v[100:103]
    ds_read_b64_tr_b16 v[228:229], v44
    v_mfma_f32_16x16x32_bf16 v[104:107], v[200:203], v[160:163], v[104:107]
    ds_read_b64_tr_b16 v[230:231], v45
    s_add_u32 m0, s83, 1024
    v_mfma_f32_16x16x32_bf16 v[108:111], v[204:207], v[160:163], v[108:111]
    buffer_load_dwordx4 v47, s[32:35], s69 offen lds
    v_mfma_f32_16x16x32_bf16 v[112:115], v[208:211], v[160:163], v[112:115]
    ds_read_b128 v[176:179], v42
    v_mfma_f32_16x16x32_bf16 v[116:119], v[212:215], v[160:163], v[116:119]
    ds_read_b128 v[180:183], v40 offset:2048
    v_mfma_f32_16x16x32_bf16 v[120:123], v[200:203], v[164:167], v[120:123]
    ds_read_b128 v[184:187], v40 offset:4096
    s_add_u32 m0, s83, 2048
    v_mfma_f32_16x16x32_bf16 v[124:127], v[204:207], v[164:167], v[124:127]
    buffer_load_dwordx4 v48, s[32:35], s69 offen lds
    v_mfma_f32_16x16x32_bf16 v[128:131], v[208:211], v[164:167], v[128:131]
    ds_read_b128 v[188:191], v40 offset:6144
    v_mfma_f32_16x16x32_bf16 v[132:135], v[212:215], v[164:167], v[132:135]
    ds_read_b128 v[192:195], v40 offset:8192
    v_mfma_f32_16x16x32_bf16 v[136:139], v[200:203], v[168:171], v[136:139]
    ds_read_b128 v[196:199], v43
    v_mfma_f32_16x16x32_bf16 v[140:143], v[204:207], v[168:171], v[140:143]
    s_mov_b32 s67, s66
    s_add_u32 s66, s66, 40960
    s_cmp_eq_u32 s66, 122880
    v_mfma_f32_16x16x32_bf16 v[144:147], v[208:211], v[168:171], v[144:147]
    s_cselect_b32 s66, 0, s66
    v_add_u32 v41, s66, v31
    v_add_u32 v39, s66, v29
    v_mfma_f32_16x16x32_bf16 v[148:151], v[212:215], v[168:171], v[148:151]
    v_add_u32 v40, s66, v30
    v_mfma_f32_16x16x32_bf16 v[64:67], v[152:155], v[152:155], v[64:67]
    v_mfma_f32_16x16x32_bf16 v[68:71], v[172:175], v[172:175], v[68:71]
    s_waitcnt vmcnt(13) lgkmcnt(0)
    s_barrier
    s_mov_b32 s63, 0
L_p1_tag:
    v_readfirstlane_b32 s4, v58
    v_readfirstlane_b32 s5, v59
    s_add_u32 s63, s63, 1
    s_cmp_lg_u32 s4, 0
    s_cbranch_scc1 L_p1_tagged
    global_load_dwordx2 v[58:59], v60, s[20:21] sc1
    s_waitcnt vmcnt(0)
    s_cmp_lt_u32 s63, 0x20000
    s_cbranch_scc1 L_p1_tag
L_p1_tagged:
    v_mfma_f32_16x16x32_bf16 v[72:75], v[216:219], v[176:179], v[72:75]
    ds_read_b64_tr_b16 v[200:201], v41 offset:0
    v_mad_u32_u24 v44, v33, s66, v240
    v_mfma_f32_16x16x32_bf16 v[76:79], v[220:223], v[176:179], v[76:79]
    ds_read_b64_tr_b16 v[202:203], v41 offset:3840
    v_mad_u32_u24 v45, v33, s66, v241
    v_mfma_f32_16x16x32_bf16 v[80:83], v[224:227], v[176:179], v[80:83]
    ds_read_b64_tr_b16 v[204:205], v41 offset:160
    s_add_u32 m0, s83, 3072
    v_mfma_f32_16x16x32_bf16 v[84:87], v[228:231], v[176:179], v[84:87]
    buffer_load_dwordx4 v49, s[32:35], s69 offen lds
    v_mfma_f32_16x16x32_bf16 v[88:91], v[216:219], v[180:183], v[88:91]
    ds_read_b64_tr_b16 v[206:207], v41 offset:4000
    v_mad_u32_u24 v42, v36, s66, v34
    v_mfma_f32_16x16x32_bf16 v[92:95], v[220:223], v[180:183], v[92:95]
    ds_read_b64_tr_b16 v[208:209], v41 offset:320
    v_mfma_f32_16x16x32_bf16 v[96:99], v[224:227], v[180:183], v[96:99]
    ds_read_b64_tr_b16 v[210:211], v41 offset:4160
    v_add_u32 v43, s66, v37
    v_mfma_f32_16x16x32_bf16 v[100:103], v[228:231], v[180:183], v[100:103]
    ds_read_b64_tr_b16 v[212:213], v44
    s_add_u32 m0, s83, 4096
    v_mfma_f32_16x16x32_bf16 v[104:107], v[216:219], v[184:187], v[104:107]
    buffer_load_dwordx4 v50, s[32:35], s69 offen lds
    v_mfma_f32_16x16x32_bf16 v[108:111], v[220:223], v[184:187], v[108:111]
    ds_read_b64_tr_b16 v[214:215], v45
    v_mfma_f32_16x16x32_bf16 v[112:115], v[224:227], v[184:187], v[112:115]
    ds_read_b128 v[152:155], v42
    s_add_u32 m0, s83, 20480
    s_add_u32 s69, s82, 163840
    v_mfma_f32_16x16x32_bf16 v[116:119], v[228:231], v[184:187], v[116:119]
    buffer_load_dwordx4 v46, s[32:35], s69 offen lds
    v_mfma_f32_16x16x32_bf16 v[120:123], v[216:219], v[188:191], v[120:123]
    ds_read_b128 v[156:159], v39 offset:2048
    v_mfma_f32_16x16x32_bf16 v[124:127], v[220:223], v[188:191], v[124:127]
    ds_read_b128 v[160:163], v39 offset:4096
    s_add_u32 m0, s83, 21504
    v_mfma_f32_16x16x32_bf16 v[128:131], v[224:227], v[188:191], v[128:131]
    buffer_load_dwordx4 v47, s[32:35], s69 offen lds
    v_mfma_f32_16x16x32_bf16 v[132:135], v[228:231], v[188:191], v[132:135]
    ds_read_b128 v[164:167], v39 offset:6144
    v_mfma_f32_16x16x32_bf16 v[136:139], v[216:219], v[192:195], v[136:139]
    ds_read_b128 v[168:171], v39 offset:8192
    v_mfma_f32_16x16x32_bf16 v[140:143], v[220:223], v[192:195], v[140:143]
    ds_read_b128 v[172:175], v43
    v_mfma_f32_16x16x32_bf16 v[144:147], v[224:227], v[192:195], v[144:147]
    v_mfma_f32_16x16x32_bf16 v[148:151], v[228:231], v[192:195], v[148:151]
    v_mfma_f32_16x16x32_bf16 v[64:67], v[176:179], v[176:179], v[64:67]
    v_mfma_f32_16x16x32_bf16 v[68:71], v[196:199], v[196:199], v[68:71]
    s_waitcnt lgkmcnt(0)
    v_mfma_f32_16x16x32_bf16 v[72:75], v[200:203], v[152:155], v[72:75]
    ds_read_b64_tr_b16 v[216:217], v41 offset:15360
    v_mad_u32_u24 v44, v33, s66, v242
    v_mfma_f32_16x16x32_bf16 v[76:79], v[204:207], v[152:155], v[76:79]
    ds_read_b64_tr_b16 v[218:219], v41 offset:19200
    v_mad_u32_u24 v45, v33, s66, v243
    v_mfma_f32_16x16x32_bf16 v[80:83], v[208:211], v[152:155], v[80:83]
    ds_read_b64_tr_b16 v[220:221], v41 offset:15520
    s_add_u32 m0, s83, 22528
    v_mfma_f32_16x16x32_bf16 v[84:87], v[212:215], v[152:155], v[84:87]
    buffer_load_dwordx4 v48, s[32:35], s69 offen lds
    v_mfma_f32_16x16x32_bf16 v[88:91], v[200:203], v[156:159], v[88:91]
    ds_read_b64_tr_b16 v[222:223], v41 offset:19360
    v_mad_u32_u24 v42, v36, s66, v35
    v_mfma_f32_16x16x32_bf16 v[92:95], v[204:207], v[156:159], v[92:95]
    ds_read_b64_tr_b16 v[224:225], v41 offset:15680
    v_mfma_f32_16x16x32_bf16 v[96:99], v[208:211], v[156:159], v[96:99]
    ds_read_b64_tr_b16 v[226:227], v41 offset:19520
    v_add_u32 v43, s66, v38
    v_mfma_f32_16x16x32_bf16 v[100:103], v[212:215], v[156:159], v[100:103]
    ds_read_b64_tr_b16 v[228:229], v44
    s_add_u32 m0, s83, 23552
    v_mfma_f32_16x16x32_bf16 v[104:107], v[200:203], v[160:163], v[104:107]
    buffer_load_dwordx4 v49, s[32:35], s69 offen lds
    v_mfma_f32_16x16x32_bf16 v[108:111], v[204:207], v[160:163], v[108:111]
    ds_read_b64_tr_b16 v[230:231], v45
    v_mfma_f32_16x16x32_bf16 v[112:115], v[208:211], v[160:163], v[112:115]
    ds_read_b128 v[176:179], v42
    s_add_u32 m0, s83, 24576
    v_mfma_f32_16x16x32_bf16 v[116:119], v[212:215], v[160:163], v[116:119]
    buffer_load_dwordx4 v50, s[32:35], s69 offen lds
    v_mfma_f32_16x16x32_bf16 v[120:123], v[200:203], v[164:167], v[120:123]
    ds_read_b128 v[180:183], v40 offset:2048
    v_mfma_f32_16x16x32_bf16 v[124:127], v[204:207], v[164:167], v[124:127]
    ds_read_b128 v[184:187], v40 offset:4096
    s_add_u32 m0, s83, 40960
    s_add_u32 s69, s82, 327680
    v_mfma_f32_16x16x32_bf16 v[128:131], v[208:211], v[164:167], v[128:131]
    buffer_load_dwordx4 v46, s[32:35], s69 offen lds
    v_mfma_f32_16x16x32_bf16 v[132:135], v[212:215], v[164:167], v[132:135]
    ds_read_b128 v[188:191], v40 offset:6144
    v_mfma_f32_16x16x32_bf16 v[136:139], v[200:203], v[168:171], v[136:139]
    ds_read_b128 v[192:195], v40 offset:8192
    v_mfma_f32_16x16x32_bf16 v[140:143], v[204:207], v[168:171], v[140:143]
    ds_read_b128 v[196:199], v43
    v_mfma_f32_16x16x32_bf16 v[144:147], v[208:211], v[168:171], v[144:147]
    v_mfma_f32_16x16x32_bf16 v[148:151], v[212:215], v[168:171], v[148:151]
    v_mfma_f32_16x16x32_bf16 v[64:67], v[152:155], v[152:155], v[64:67]
    v_mfma_f32_16x16x32_bf16 v[68:71], v[172:175], v[172:175], v[68:71]
    s_waitcnt vmcnt(11) lgkmcnt(0)
    s_barrier
    s_cmp_ge_u32 s71, 576
    s_cbranch_scc1 L_p1_rend
    s_cmp_ge_u32 s71, 384
    s_cbranch_scc1 L_p1_rd
    ds_read_b64_tr_b16 v[152:153], v252 offset:0
    ds_read_b64_tr_b16 v[154:155], v252 offset:512
    ds_read_b64_tr_b16 v[156:157], v252 offset:2560
    ds_read_b64_tr_b16 v[158:159], v252 offset:3072
    ds_read_b64_tr_b16 v[160:161], v252 offset:5120
    ds_read_b64_tr_b16 v[162:163], v252 offset:5632
    ds_read_b64_tr_b16 v[164:165], v252 offset:7680
    ds_read_b64_tr_b16 v[166:167], v252 offset:8192
    ds_read_b64_tr_b16 v[168:169], v253 offset:2048
    ds_read_b64_tr_b16 v[170:171], v253 offset:4608
    ds_read_b64_tr_b16 v[172:173], v252 offset:32
    ds_read_b64_tr_b16 v[174:175], v252 offset:544
    ds_read_b64_tr_b16 v[200:201], v252 offset:2592
    ds_read_b64_tr_b16 v[202:203], v252 offset:3104
    ds_read_b64_tr_b16 v[204:205], v252 offset:5152
    ds_read_b64_tr_b16 v[206:207], v252 offset:5664
    ds_read_b64_tr_b16 v[208:209], v252 offset:7712
    ds_read_b64_tr_b16 v[210:211], v252 offset:8224
    ds_read_b64_tr_b16 v[212:213], v253 offset:2080
    ds_read_b64_tr_b16 v[214:215], v253 offset:4640
    v_mov_b32 v52, 0
    v_mov_b32 v53, 0
    v_mov_b32 v54, 0x3f803f80
    s_waitcnt lgkmcnt(15)
    buffer_store_dwordx4 v[152:155], v3, s[52:55], s36 offen sc1
    s_add_u32 s36, s36, s38
    buffer_store_dwordx4 v[156:159], v3, s[52:55], s36 offen sc1
    s_add_u32 s36, s36, s38
    s_waitcnt lgkmcnt(14)
    buffer_store_dwordx4 v[160:163], v3, s[52:55], s36 offen sc1
    s_add_u32 s36, s36, s38
    s_waitcnt lgkmcnt(12)
    buffer_store_dwordx4 v[164:167], v3, s[52:55], s36 offen sc1
    s_waitcnt lgkmcnt(10)
    buffer_store_dwordx4 v[168:171], v3, s[52:55], s37 offen sc1
    s_waitcnt lgkmcnt(8)
    buffer_store_dwordx4 v[172:175], v3, s[52:55], s39 offen sc1
    s_add_u32 s39, s39, s41
    s_waitcnt lgkmcnt(6)
    buffer_store_dwordx4 v[200:203], v3, s[52:55], s39 offen sc1
    s_add_u32 s39, s39, s41
    s_waitcnt lgkmcnt(4)
    buffer_store_dwordx4 v[204:207], v3, s[52:55], s39 offen sc1
    s_add_u32 s39, s39, s41
    s_waitcnt lgkmcnt(2)
    buffer_store_dwordx4 v[208:211], v3, s[52:55], s39 offen sc1
    s_waitcnt lgkmcnt(0)
    buffer_store_dwordx4 v[212:215], v3, s[52:55], s40 offen sc1
    v_dot2c_f32_bf16 v52, v152, v54
    v_dot2c_f32_bf16 v53, v172, v54
    v_dot2c_f32_bf16 v52, v153, v54
    v_dot2c_f32_bf16 v53, v173, v54
    v_dot2c_f32_bf16 v52, v154, v54
    v_dot2c_f32_bf16 v53, v174, v54
    v_dot2c_f32_bf16 v52, v155, v54
    v_dot2c_f32_bf16 v53, v175, v54
    v_dot2c_f32_bf16 v52, v156, v54
    v_dot2c_f32_bf16 v53, v200, v54
    v_dot2c_f32_bf16 v52, v157, v54
    v_dot2c_f32_bf16 v53, v201, v54
    v_dot2c_f32_bf16 v52, v158, v54
    v_dot2c_f32_bf16 v53, v202, v54
    v_dot2c_f32_bf16 v52, v159, v54
    v_dot2c_f32_bf16 v53, v203, v54
    v_dot2c_f32_bf16 v52, v160, v54
    v_dot2c_f32_bf16 v53, v204, v54
    v_dot2c_f32_bf16 v52, v161, v54
    v_dot2c_f32_bf16 v53, v205, v54
    v_dot2c_f32_bf16 v52, v162, v54
    v_dot2c_f32_bf16 v53, v206, v54
    v_dot2c_f32_bf16 v52, v163, v54
    v_dot2c_f32_bf16 v53, v207, v54
    v_dot2c_f32_bf16 v52, v164, v54
    v_dot2c_f32_bf16 v53, v208, v54
    v_dot2c_f32_bf16 v52, v165, v54
    v_dot2c_f32_bf16 v53, v209, v54
    v_dot2c_f32_bf16 v52, v166, v54
    v_dot2c_f32_bf16 v53, v210, v54
    v_dot2c_f32_bf16 v52, v167, v54
    v_dot2c_f32_bf16 v53, v211, v54
    v_dot2c_f32_bf16 v52, v168, v54
    v_dot2c_f32_bf16 v53, v212, v54
    v_dot2c_f32_bf16 v52, v169, v54
    v_dot2c_f32_bf16 v53, v213, v54
    v_dot2c_f32_bf16 v52, v170, v54
    v_dot2c_f32_bf16 v53, v214, v54
    v_dot2c_f32_bf16 v52, v171, v54
    v_dot2c_f32_bf16 v53, v215, v54
    v_lshlrev_b32 v54, 2, v0
    s_nop 1
    v_permlane32_swap_b32 v52, v53
    v_add_f32 v52, v52, v53
    buffer_store_dword v52, v54, s[52:55], s42 offen sc1
    s_branch L_p1_rend
L_p1_rd:
    ds_read_b64_tr_b16 v[152:153], v252 offset:0
    ds_read_b64_tr_b16 v[154:155], v252 offset:1280
    ds_read_b64_tr_b16 v[156:157], v252 offset:8
    ds_read_b64_tr_b16 v[158:159], v252 offset:1288
    ds_read_b64_tr_b16 v[160:161], v252 offset:16
    ds_read_b64_tr_b16 v[162:163], v252 offset:1296
    ds_read_b64_tr_b16 v[164:165], v252 offset:24
    ds_read_b64_tr_b16 v[166:167], v252 offset:1304
    ds_read_b64_tr_b16 v[168:169], v252 offset:32
    ds_read_b64_tr_b16 v[170:171], v252 offset:1312
    ds_read_b64_tr_b16 v[172:173], v252 offset:5120
    ds_read_b64_tr_b16 v[174:175], v252 offset:6400
    ds_read_b64_tr_b16 v[200:201], v252 offset:5128
    ds_read_b64_tr_b16 v[202:203], v252 offset:6408
    ds_read_b64_tr_b16 v[204:205], v252 offset:5136
    ds_read_b64_tr_b16 v[206:207], v252 offset:6416
    ds_read_b64_tr_b16 v[208:209], v252 offset:5144
    ds_read_b64_tr_b16 v[210:211], v252 offset:6424
    ds_read_b64_tr_b16 v[212:213], v252 offset:5152
    ds_read_b64_tr_b16 v[214:215], v252 offset:6432
    s_waitcnt lgkmcnt(15)
    buffer_store_dwordx4 v[152:155], v3, s[52:55], s36 offen offset:0 sc1
    buffer_store_dwordx4 v[156:159], v3, s[52:55], s36 offen offset:1024 sc1
    s_waitcnt lgkmcnt(14)
    buffer_store_dwordx4 v[160:163], v3, s[52:55], s36 offen offset:2048 sc1
    s_waitcnt lgkmcnt(12)
    buffer_store_dwordx4 v[164:167], v3, s[52:55], s36 offen offset:3072 sc1
    s_waitcnt lgkmcnt(10)
    s_add_u32 s36, s36, 4096
    buffer_store_dwordx4 v[168:171], v3, s[52:55], s36 offen offset:0 sc1
    s_waitcnt lgkmcnt(8)
    buffer_store_dwordx4 v[172:175], v3, s[52:55], s37 offen offset:0 sc1
    s_waitcnt lgkmcnt(6)
    buffer_store_dwordx4 v[200:203], v3, s[52:55], s37 offen offset:1024 sc1
    s_waitcnt lgkmcnt(4)
    buffer_store_dwordx4 v[204:207], v3, s[52:55], s37 offen offset:2048 sc1
    s_waitcnt lgkmcnt(2)
    buffer_store_dwordx4 v[208:211], v3, s[52:55], s37 offen offset:3072 sc1
    s_waitcnt lgkmcnt(0)
    s_add_u32 s37, s37, 4096
    buffer_store_dwordx4 v[212:215], v3, s[52:55], s37 offen offset:0 sc1
L_p1_rend:
    s_nop 1
    v_mfma_f32_16x16x32_bf16 v[72:75], v[216:219], v[176:179], v[72:75]
    s_add_u32 m0, s83, 41984
    s_nop 0
    buffer_load_dwordx4 v47, s[32:35], s69 offen lds
    v_mfma_f32_16x16x32_bf16 v[76:79], v[220:223], v[176:179], v[76:79]
    s_add_u32 m0, s83, 43008
    s_nop 0
    buffer_load_dwordx4 v48, s[32:35], s69 offen lds
    v_mfma_f32_16x16x32_bf16 v[80:83], v[224:227], v[176:179], v[80:83]
    s_add_u32 m0, s83, 44032
    s_nop 0
    buffer_load_dwordx4 v49, s[32:35], s69 offen lds
    v_mfma_f32_16x16x32_bf16 v[84:87], v[228:231], v[176:179], v[84:87]
    s_add_u32 m0, s83, 45056
    s_nop 0
    buffer_load_dwordx4 v50, s[32:35], s69 offen lds
    v_mfma_f32_16x16x32_bf16 v[88:91], v[216:219], v[180:183], v[88:91]
    v_mfma_f32_16x16x32_bf16 v[92:95], v[220:223], v[180:183], v[92:95]
    v_mfma_f32_16x16x32_bf16 v[96:99], v[224:227], v[180:183], v[96:99]
    v_mfma_f32_16x16x32_bf16 v[100:103], v[228:231], v[180:183], v[100:103]
    v_mfma_f32_16x16x32_bf16 v[104:107], v[216:219], v[184:187], v[104:107]
    v_mfma_f32_16x16x32_bf16 v[108:111], v[220:223], v[184:187], v[108:111]
    v_mfma_f32_16x16x32_bf16 v[112:115], v[224:227], v[184:187], v[112:115]
    v_mfma_f32_16x16x32_bf16 v[116:119], v[228:231], v[184:187], v[116:119]
    v_mfma_f32_16x16x32_bf16 v[120:123], v[216:219], v[188:191], v[120:123]
    v_mfma_f32_16x16x32_bf16 v[124:127], v[220:223], v[188:191], v[124:127]
    v_mfma_f32_16x16x32_bf16 v[128:131], v[224:227], v[188:191], v[128:131]
    v_mfma_f32_16x16x32_bf16 v[132:135], v[228:231], v[188:191], v[132:135]
    v_mfma_f32_16x16x32_bf16 v[136:139], v[216:219], v[192:195], v[136:139]
    v_mfma_f32_16x16x32_bf16 v[140:143], v[220:223], v[192:195], v[140:143]
    v_mfma_f32_16x16x32_bf16 v[144:147], v[224:227], v[192:195], v[144:147]
    v_mfma_f32_16x16x32_bf16 v[148:151], v[228:231], v[192:195], v[148:151]
    v_mfma_f32_16x16x32_bf16 v[64:67], v[176:179], v[176:179], v[64:67]
    v_mfma_f32_16x16x32_bf16 v[68:71], v[196:199], v[196:199], v[68:71]
    v_lshlrev_b32 v4, 2, v1
    v_add_u32 v5, 192, v4
    v_and_b32 v6, 3, v0
    ds_bpermute_b32 v168, v5, v84
    ds_bpermute_b32 v169, v5, v100
    ds_bpermute_b32 v170, v5, v116
    ds_bpermute_b32 v171, v5, v132
    ds_bpermute_b32 v172, v5, v148
    v_cmp_eq_u32 vcc, 1, v6
    s_nop 1
    v_cndmask_b32 v64, v64, v65, vcc
    v_cndmask_b32 v68, v68, v69, vcc
    v_cmp_eq_u32 vcc, 2, v6
    s_nop 1
    v_cndmask_b32 v64, v64, v66, vcc
    v_cndmask_b32 v68, v68, v70, vcc
    v_cmp_eq_u32 vcc, 3, v6
    s_nop 1
    v_cndmask_b32 v64, v64, v67, vcc
    v_cndmask_b32 v68, v68, v71, vcc
    s_lshl_b32 s63, s56, 6
    v_add_u32 v4, 153664, v4
    v_add_u32 v6, s63, v4
    s_mov_b32 exec_lo, 0x00f0000f
    s_mov_b32 exec_hi, 0xf0000f00
    ds_write_b32 v4, v64
    ds_write_b32 v6, v68 offset:64
    s_mov_b64 exec, -1
    v_mov_b32_dpp v152, v72 row_newbcast:0 row_mask:0xf bank_mask:0xf
    v_mov_b32_dpp v153, v73 row_newbcast:0 row_mask:0xf bank_mask:0xf
    v_mov_b32_dpp v154, v74 row_newbcast:0 row_mask:0xf bank_mask:0xf
    v_mov_b32_dpp v155, v75 row_newbcast:0 row_mask:0xf bank_mask:0xf
    v_mov_b32_dpp v156, v76 row_newbcast:0 row_mask:0xf bank_mask:0xf
    v_mov_b32_dpp v157, v77 row_newbcast:0 row_mask:0xf bank_mask:0xf
    v_mov_b32_dpp v158, v78 row_newbcast:0 row_mask:0xf bank_mask:0xf
    v_mov_b32_dpp v159, v79 row_newbcast:0 row_mask:0xf bank_mask:0xf
    v_mov_b32_dpp v160, v80 row_newbcast:0 row_mask:0xf bank_mask:0xf
    v_mov_b32_dpp v161, v81 row_newbcast:0 row_mask:0xf bank_mask:0xf
    v_mov_b32_dpp v162, v82 row_newbcast:0 row_mask:0xf bank_mask:0xf
    v_mov_b32_dpp v163, v83 row_newbcast:0 row_mask:0xf bank_mask:0xf
    v_mov_b32_dpp v164, v84 row_newbcast:0 row_mask:0xf bank_mask:0xf
    v_mov_b32_dpp v165, v85 row_newbcast:0 row_mask:0xf bank_mask:0xf
    v_mov_b32_dpp v166, v86 row_newbcast:0 row_mask:0xf bank_mask:0xf
    v_mov_b32_dpp v167, v87 row_newbcast:0 row_mask:0xf bank_mask:0xf
    s_mov_b32 s63, 0xbacccccd
    s_mov_b32 s64, 0x3acccccd
    s_mov_b32 s74, 0
    s_mov_b32 s75, 0xffff0000
    s_waitcnt lgkmcnt(0)
    s_barrier
    ds_read_b32 v198, v4 offset:0
    ds_read_b32 v199, v4 offset:64
    ds_read_b32 v200, v4 offset:128
    ds_read_b32 v201, v4 offset:192
    ds_read_b32 v202, v4 offset:256
    v_mul_f32 v174, s63, v168
    v_mul_f32 v175, s63, v169
    v_mul_f32 v176, s63, v170
    v_mul_f32 v177, s63, v171
    v_mul_f32 v178, s63, v172
    v_mul_f32 v192, v174, v174
    v_mul_f32 v193, v175, v175
    v_mul_f32 v194, v176, v176
    v_mul_f32 v195, v177, v177
    v_mul_f32 v196, v178, v178
    v_pk_fma_f32 v[80:81], v[160:161], v[174:175], v[80:81] op_sel:[0,0,0] op_sel_hi:[1,0,1]
    v_pk_fma_f32 v[82:83], v[162:163], v[174:175], v[82:83] op_sel:[0,0,0] op_sel_hi:[1,0,1]
    v_pk_fma_f32 v[96:97], v[160:161], v[174:175], v[96:97] op_sel:[0,1,0] op_sel_hi:[1,1,1]
    v_pk_fma_f32 v[98:99], v[162:163], v[174:175], v[98:99] op_sel:[0,1,0] op_sel_hi:[1,1,1]
    v_pk_fma_f32 v[112:113], v[160:161], v[176:177], v[112:113] op_sel:[0,0,0] op_sel_hi:[1,0,1]
    v_pk_fma_f32 v[114:115], v[162:163], v[176:177], v[114:115] op_sel:[0,0,0] op_sel_hi:[1,0,1]
    v_pk_fma_f32 v[128:129], v[160:161], v[176:177], v[128:129] op_sel:[0,1,0] op_sel_hi:[1,1,1]
    v_pk_fma_f32 v[130:131], v[162:163], v[176:177], v[130:131] op_sel:[0,1,0] op_sel_hi:[1,1,1]
    s_add_u32 m0, s83, 61440
    s_add_u32 s69, s82, 491520
    buffer_load_dwordx4 v46, s[32:35], s69 offen lds
    v_pk_fma_f32 v[144:145], v[160:161], v[178:179], v[144:145] op_sel:[0,0,0] op_sel_hi:[1,0,1]
    v_pk_fma_f32 v[146:147], v[162:163], v[178:179], v[146:147] op_sel:[0,0,0] op_sel_hi:[1,0,1]
    v_pk_fma_f32 v[84:85], v[164:165], v[174:175], v[84:85] op_sel:[0,0,0] op_sel_hi:[1,0,1]
    v_pk_fma_f32 v[86:87], v[166:167], v[174:175], v[86:87] op_sel:[0,0,0] op_sel_hi:[1,0,1]
    v_pk_fma_f32 v[100:101], v[164:165], v[174:175], v[100:101] op_sel:[0,1,0] op_sel_hi:[1,1,1]
    v_pk_fma_f32 v[102:103], v[166:167], v[174:175], v[102:103] op_sel:[0,1,0] op_sel_hi:[1,1,1]
    v_pk_fma_f32 v[116:117], v[164:165], v[176:177], v[116:117] op_sel:[0,0,0] op_sel_hi:[1,0,1]
    v_pk_fma_f32 v[118:119], v[166:167], v[176:177], v[118:119] op_sel:[0,0,0] op_sel_hi:[1,0,1]
    s_add_u32 m0, s83, 62464
    s_nop 0
    buffer_load_dwordx4 v47, s[32:35], s69 offen lds
    v_pk_fma_f32 v[132:133], v[164:165], v[176:177], v[132:133] op_sel:[0,1,0] op_sel_hi:[1,1,1]
    v_pk_fma_f32 v[134:135], v[166:167], v[176:177], v[134:135] op_sel:[0,1,0] op_sel_hi:[1,1,1]
    v_pk_fma_f32 v[148:149], v[164:165], v[178:179], v[148:149] op_sel:[0,0,0] op_sel_hi:[1,0,1]
    v_pk_fma_f32 v[150:151], v[166:167], v[178:179], v[150:151] op_sel:[0,0,0] op_sel_hi:[1,0,1]
    v_pk_fma_f32 v[76:77], v[156:157], v[174:175], v[76:77] op_sel:[0,0,0] op_sel_hi:[1,0,1]
    v_pk_fma_f32 v[78:79], v[158:159], v[174:175], v[78:79] op_sel:[0,0,0] op_sel_hi:[1,0,1]
    v_pk_fma_f32 v[92:93], v[156:157], v[174:175], v[92:93] op_sel:[0,1,0] op_sel_hi:[1,1,1]
    v_pk_fma_f32 v[94:95], v[158:159], v[174:175], v[94:95] op_sel:[0,1,0] op_sel_hi:[1,1,1]
    s_add_u32 m0, s83, 63488
    s_nop 0
    buffer_load_dwordx4 v48, s[32:35], s69 offen lds
    v_pk_fma_f32 v[108:109], v[156:157], v[176:177], v[108:109] op_sel:[0,0,0] op_sel_hi:[1,0,1]
    v_pk_fma_f32 v[110:111], v[158:159], v[176:177], v[110:111] op_sel:[0,0,0] op_sel_hi:[1,0,1]
    v_pk_fma_f32 v[124:125], v[156:157], v[176:177], v[124:125] op_sel:[0,1,0] op_sel_hi:[1,1,1]
    v_pk_fma_f32 v[126:127], v[158:159], v[176:177], v[126:127] op_sel:[0,1,0] op_sel_hi:[1,1,1]
    v_pk_fma_f32 v[140:141], v[156:157], v[178:179], v[140:141] op_sel:[0,0,0] op_sel_hi:[1,0,1]
    v_pk_fma_f32 v[142:143], v[158:159], v[178:179], v[142:143] op_sel:[0,0,0] op_sel_hi:[1,0,1]
    v_pk_fma_f32 v[88:89], v[152:153], v[174:175], v[88:89] op_sel:[0,1,0] op_sel_hi:[1,1,1]
    v_pk_fma_f32 v[90:91], v[154:155], v[174:175], v[90:91] op_sel:[0,1,0] op_sel_hi:[1,1,1]
    v_pk_fma_f32 v[104:105], v[152:153], v[176:177], v[104:105] op_sel:[0,0,0] op_sel_hi:[1,0,1]
    v_pk_fma_f32 v[106:107], v[154:155], v[176:177], v[106:107] op_sel:[0,0,0] op_sel_hi:[1,0,1]
    v_pk_fma_f32 v[120:121], v[152:153], v[176:177], v[120:121] op_sel:[0,1,0] op_sel_hi:[1,1,1]
    v_pk_fma_f32 v[122:123], v[154:155], v[176:177], v[122:123] op_sel:[0,1,0] op_sel_hi:[1,1,1]
    v_pk_fma_f32 v[136:137], v[152:153], v[178:179], v[136:137] op_sel:[0,0,0] op_sel_hi:[1,0,1]
    v_pk_fma_f32 v[138:139], v[154:155], v[178:179], v[138:139] op_sel:[0,0,0] op_sel_hi:[1,0,1]
    s_waitcnt lgkmcnt(0)
    v_fma_f32 v192, v198, s64, -v192
    v_fma_f32 v193, v199, s64, -v193
    v_fma_f32 v194, v200, s64, -v194
    v_fma_f32 v195, v201, s64, -v195
    v_fma_f32 v196, v202, s64, -v196
    v_max_f32 v192, 0, v192
    v_max_f32 v193, 0, v193
    v_max_f32 v194, 0, v194
    v_max_f32 v195, 0, v195
    v_max_f32 v196, 0, v196
    v_add_f32 v192, 0x3727c5ac, v192
    v_add_f32 v193, 0x3727c5ac, v193
    v_add_f32 v194, 0x3727c5ac, v194
    v_add_f32 v195, 0x3727c5ac, v195
    v_add_f32 v196, 0x3727c5ac, v196
    s_add_u32 m0, s83, 64512
    s_nop 0
    buffer_load_dwordx4 v49, s[32:35], s69 offen lds
    v_rsq_f32 v180, v192
    v_rsq_f32 v181, v193
    v_rsq_f32 v182, v194
    v_rsq_f32 v183, v195
    v_rsq_f32 v184, v196
    v_cndmask_b32 v186, v180, 0, s[74:75]
    v_cndmask_b32 v187, v181, 0, s[74:75]
    v_cndmask_b32 v188, v182, 0, s[74:75]
    v_cndmask_b32 v189, v183, 0, s[74:75]
    v_cndmask_b32 v190, v184, 0, s[74:75]
    s_add_u32 m0, s83, 65536
    s_nop 0
    buffer_load_dwordx4 v50, s[32:35], s69 offen lds
    s_waitcnt vmcnt(9)
    s_barrier
    s_mov_b32 s63, 0
    s_cmp_lg_u32 s56, 0
    s_cbranch_scc1 L_pub_p0
    s_mul_i32 s60, s63, 0
    s_add_u32 s60, s60, s2
    s_lshl_b32 s60, s60, 3
    s_add_u32 s60, s60, 18939904
    v_mov_b32 v8, s4
    v_mov_b32 v9, s5
    v_lshlrev_b32 v10, 3, v0
    s_mov_b64 exec, 0x1
    buffer_store_dwordx2 v[8:9], v10, s[52:55], s60 offen sc1
    s_mov_b64 exec, -1
L_pub_p0:
    v_pk_mul_f32 v[80:81], v[80:81], v[180:181] op_sel:[0,0] op_sel_hi:[1,0]
    v_pk_mul_f32 v[82:83], v[82:83], v[180:181] op_sel:[0,0] op_sel_hi:[1,0]
    v_cvt_pk_bf16_f32 v204, v80, v81
    v_cvt_pk_bf16_f32 v205, v82, v83
    ds_write_b64 v24, v[204:205] offset:0
    v_pk_mul_f32 v[84:85], v[84:85], v[186:187] op_sel:[0,0] op_sel_hi:[1,0]
    v_pk_mul_f32 v[86:87], v[86:87], v[186:187] op_sel:[0,0] op_sel_hi:[1,0]
    v_cvt_pk_bf16_f32 v234, v84, v85
    v_cvt_pk_bf16_f32 v235, v86, v87
    v_pk_mul_f32 v[96:97], v[96:97], v[180:181] op_sel:[0,1] op_sel_hi:[1,1]
    v_pk_mul_f32 v[98:99], v[98:99], v[180:181] op_sel:[0,1] op_sel_hi:[1,1]
    v_cvt_pk_bf16_f32 v206, v96, v97
    v_cvt_pk_bf16_f32 v207, v98, v99
    ds_write_b64 v24, v[206:207] offset:640
    v_pk_mul_f32 v[100:101], v[100:101], v[186:187] op_sel:[0,1] op_sel_hi:[1,1]
    v_pk_mul_f32 v[102:103], v[102:103], v[186:187] op_sel:[0,1] op_sel_hi:[1,1]
    v_cvt_pk_bf16_f32 v238, v100, v101
    v_cvt_pk_bf16_f32 v239, v102, v103
    v_pk_mul_f32 v[112:113], v[112:113], v[182:183] op_sel:[0,0] op_sel_hi:[1,0]
    v_pk_mul_f32 v[114:115], v[114:115], v[182:183] op_sel:[0,0] op_sel_hi:[1,0]
    v_cvt_pk_bf16_f32 v208, v112, v113
    v_cvt_pk_bf16_f32 v209, v114, v115
    ds_write_b64 v24, v[208:209] offset:1280
    v_pk_mul_f32 v[116:117], v[116:117], v[188:189] op_sel:[0,0] op_sel_hi:[1,0]
    v_pk_mul_f32 v[118:119], v[118:119], v[188:189] op_sel:[0,0] op_sel_hi:[1,0]
    v_cvt_pk_bf16_f32 v242, v116, v117
    v_cvt_pk_bf16_f32 v243, v118, v119
    v_pk_mul_f32 v[128:129], v[128:129], v[182:183] op_sel:[0,1] op_sel_hi:[1,1]
    v_pk_mul_f32 v[130:131], v[130:131], v[182:183] op_sel:[0,1] op_sel_hi:[1,1]
    v_cvt_pk_bf16_f32 v210, v128, v129
    v_cvt_pk_bf16_f32 v211, v130, v131
    ds_write_b64 v24, v[210:211] offset:1920
    v_pk_mul_f32 v[132:133], v[132:133], v[188:189] op_sel:[0,1] op_sel_hi:[1,1]
    v_pk_mul_f32 v[134:135], v[134:135], v[188:189] op_sel:[0,1] op_sel_hi:[1,1]
    v_cvt_pk_bf16_f32 v246, v132, v133
    v_cvt_pk_bf16_f32 v247, v134, v135
    s_add_u32 m0, s83, 81920
    s_add_u32 s69, s82, 655360
    buffer_load_dwordx4 v46, s[32:35], s69 offen lds
    v_pk_mul_f32 v[144:145], v[144:145], v[184:185] op_sel:[0,0] op_sel_hi:[1,0]
    v_pk_mul_f32 v[146:147], v[146:147], v[184:185] op_sel:[0,0] op_sel_hi:[1,0]
    v_cvt_pk_bf16_f32 v212, v144, v145
    v_cvt_pk_bf16_f32 v213, v146, v147
    ds_write_b64 v24, v[212:213] offset:2560
    v_pk_mul_f32 v[148:149], v[148:149], v[190:191] op_sel:[0,0] op_sel_hi:[1,0]
    v_pk_mul_f32 v[150:151], v[150:151], v[190:191] op_sel:[0,0] op_sel_hi:[1,0]
    v_cvt_pk_bf16_f32 v250, v148, v149
    v_cvt_pk_bf16_f32 v251, v150, v151
    s_mov_b32 exec_lo, 0
    s_mov_b32 exec_hi, 0xffff
    ds_write_b64 v25, v[234:235] offset:32
    ds_write_b64 v25, v[238:239] offset:672
    ds_write_b64 v25, v[242:243] offset:1312
    ds_write_b64 v25, v[246:247] offset:1952
    ds_write_b64 v25, v[250:251] offset:2592
    s_mov_b64 exec, -1
    v_pk_mul_f32 v[76:77], v[76:77], v[180:181] op_sel:[0,0] op_sel_hi:[1,0]
    v_pk_mul_f32 v[78:79], v[78:79], v[180:181] op_sel:[0,0] op_sel_hi:[1,0]
    v_cvt_pk_bf16_f32 v232, v76, v77
    v_cvt_pk_bf16_f32 v233, v78, v79
    s_add_u32 m0, s83, 82944
    s_nop 0
    buffer_load_dwordx4 v47, s[32:35], s69 offen lds
    v_pk_mul_f32 v[92:93], v[92:93], v[180:181] op_sel:[0,1] op_sel_hi:[1,1]
    v_pk_mul_f32 v[94:95], v[94:95], v[180:181] op_sel:[0,1] op_sel_hi:[1,1]
    v_cvt_pk_bf16_f32 v236, v92, v93
    v_cvt_pk_bf16_f32 v237, v94, v95
    v_pk_mul_f32 v[88:89], v[88:89], v[180:181] op_sel:[0,1] op_sel_hi:[1,1]
    v_pk_mul_f32 v[90:91], v[90:91], v[180:181] op_sel:[0,1] op_sel_hi:[1,1]
    v_cvt_pk_bf16_f32 v214, v88, v89
    v_cvt_pk_bf16_f32 v215, v90, v91
    v_mov_b64 v[216:217], 0
    s_add_u32 m0, s83, 83968
    s_nop 0
    buffer_load_dwordx4 v48, s[32:35], s69 offen lds
    v_pk_mul_f32 v[108:109], v[108:109], v[182:183] op_sel:[0,0] op_sel_hi:[1,0]
    v_pk_mul_f32 v[110:111], v[110:111], v[182:183] op_sel:[0,0] op_sel_hi:[1,0]
    v_cvt_pk_bf16_f32 v240, v108, v109
    v_cvt_pk_bf16_f32 v241, v110, v111
    v_pk_mul_f32 v[104:105], v[104:105], v[182:183] op_sel:[0,0] op_sel_hi:[1,0]
    v_pk_mul_f32 v[106:107], v[106:107], v[182:183] op_sel:[0,0] op_sel_hi:[1,0]
    v_cvt_pk_bf16_f32 v218, v104, v105
    v_cvt_pk_bf16_f32 v219, v106, v107
    v_mov_b64 v[220:221], 0
    v_pk_mul_f32 v[124:125], v[124:125], v[182:183] op_sel:[0,1] op_sel_hi:[1,1]
    v_pk_mul_f32 v[126:127], v[126:127], v[182:183] op_sel:[0,1] op_sel_hi:[1,1]
    v_cvt_pk_bf16_f32 v244, v124, v125
    v_cvt_pk_bf16_f32 v245, v126, v127
    v_pk_mul_f32 v[120:121], v[120:121], v[182:183] op_sel:[0,1] op_sel_hi:[1,1]
    v_pk_mul_f32 v[122:123], v[122:123], v[182:183] op_sel:[0,1] op_sel_hi:[1,1]
    v_cvt_pk_bf16_f32 v222, v120, v121
    v_cvt_pk_bf16_f32 v223, v122, v123
    v_mov_b64 v[224:225], 0
    s_add_u32 m0, s83, 84992
    s_nop 0
    buffer_load_dwordx4 v49, s[32:35], s69 offen lds
    v_pk_mul_f32 v[140:141], v[140:141], v[184:185] op_sel:[0,0] op_sel_hi:[1,0]
    v_pk_mul_f32 v[142:143], v[142:143], v[184:185] op_sel:[0,0] op_sel_hi:[1,0]
    v_cvt_pk_bf16_f32 v248, v140, v141
    v_cvt_pk_bf16_f32 v249, v142, v143
    v_pk_mul_f32 v[136:137], v[136:137], v[184:185] op_sel:[0,0] op_sel_hi:[1,0]
    v_pk_mul_f32 v[138:139], v[138:139], v[184:185] op_sel:[0,0] op_sel_hi:[1,0]
    v_cvt_pk_bf16_f32 v226, v136, v137
    v_cvt_pk_bf16_f32 v227, v138, v139
    v_mov_b64 v[228:229], 0
    s_add_u32 m0, s83, 86016
    s_nop 0
    buffer_load_dwordx4 v50, s[32:35], s69 offen lds
    v_permlane16_swap_b32 v238, v216
    v_permlane16_swap_b32 v239, v217
    v_permlane16_swap_b32 v242, v220
    v_permlane16_swap_b32 v243, v221
    v_permlane16_swap_b32 v246, v224
    v_permlane16_swap_b32 v247, v225
    v_permlane16_swap_b32 v250, v228
    v_permlane16_swap_b32 v251, v229
    s_waitcnt lgkmcnt(0)
    v_mfma_f32_16x16x32_bf16 v[92:95], v[232:235], v[214:217], 0
    ds_read_b64_tr_b16 v[72:73], v14 offset:0
    v_mfma_f32_16x16x32_bf16 v[96:99], v[236:239], v[214:217], 0
    ds_read_b64_tr_b16 v[82:83], v15 offset:32
    v_mfma_f32_16x16x32_bf16 v[100:103], v[236:239], v[218:221], 0
    ds_read_b64_tr_b16 v[74:75], v14 offset:640
    v_mfma_f32_16x16x32_bf16 v[104:107], v[240:243], v[218:221], 0
    ds_read_b64_tr_b16 v[84:85], v15 offset:672
    v_mfma_f32_16x16x32_bf16 v[108:111], v[240:243], v[222:225], 0
    ds_read_b64_tr_b16 v[76:77], v14 offset:1280
    v_mfma_f32_16x16x32_bf16 v[112:115], v[244:247], v[222:225], 0
    ds_read_b64_tr_b16 v[86:87], v15 offset:1312
    v_mfma_f32_16x16x32_bf16 v[116:119], v[244:247], v[226:229], 0
    ds_read_b64_tr_b16 v[78:79], v14 offset:1920
    v_mfma_f32_16x16x32_bf16 v[120:123], v[248:251], v[226:229], 0
    ds_read_b64_tr_b16 v[88:89], v15 offset:1952
    ds_read_b64_tr_b16 v[80:81], v14 offset:2560
    ds_read_b64_tr_b16 v[90:91], v15 offset:2592
    s_mov_b32 s74, 0xaaaaaaaa
    s_mov_b32 s75, 0xaaaaaaaa
    v_mov_b32 v145, 0x3ea52b5c
    v_mov_b32 v144, s59
    v_cndmask_b32 v92, v92, v93, s[74:75]
    v_cndmask_b32 v93, v94, v95, s[74:75]
    v_cndmask_b32 v94, v96, v97, s[74:75]
    v_cndmask_b32 v95, v98, v99, s[74:75]
    v_cndmask_b32 v100, v100, v101, s[74:75]
    v_cndmask_b32 v101, v102, v103, s[74:75]
    v_cndmask_b32 v102, v104, v105, s[74:75]
    v_cndmask_b32 v103, v106, v107, s[74:75]
    v_cndmask_b32 v108, v108, v109, s[74:75]
    v_cndmask_b32 v109, v110, v111, s[74:75]
    v_cndmask_b32 v110, v112, v113, s[74:75]
    v_cndmask_b32 v111, v114, v115, s[74:75]
    v_cndmask_b32 v116, v116, v117, s[74:75]
    v_cndmask_b32 v117, v118, v119, s[74:75]
    v_cndmask_b32 v118, v120, v121, s[74:75]
    v_cndmask_b32 v119, v122, v123, s[74:75]
    v_pk_fma_f32 v[92:93], v[92:93], v[144:145], v[20:21] op_sel:[0,0,0] op_sel_hi:[1,0,1]
    v_pk_fma_f32 v[94:95], v[94:95], v[144:145], v[18:19] op_sel:[0,1,0] op_sel_hi:[1,1,1]
    v_pk_fma_f32 v[100:101], v[100:101], v[144:145], v[16:17] op_sel:[0,1,0] op_sel_hi:[1,1,1]
    v_pk_fma_f32 v[102:103], v[102:103], v[144:145], v[18:19] op_sel:[0,1,0] op_sel_hi:[1,1,1]
    v_pk_fma_f32 v[108:109], v[108:109], v[144:145], v[16:17] op_sel:[0,1,0] op_sel_hi:[1,1,1]
    v_pk_fma_f32 v[110:111], v[110:111], v[144:145], v[18:19] op_sel:[0,1,0] op_sel_hi:[1,1,1]
    v_pk_fma_f32 v[116:117], v[116:117], v[144:145], v[16:17] op_sel:[0,1,0] op_sel_hi:[1,1,1]
    v_pk_fma_f32 v[118:119], v[118:119], v[144:145], v[18:19] op_sel:[0,1,0] op_sel_hi:[1,1,1]
    v_max3_f32 v124, v92, v93, v94
    v_max3_f32 v125, v100, v101, v102
    v_max3_f32 v126, v108, v109, v110
    v_max3_f32 v127, v116, v117, v118
    v_max_f32 v124, v124, v95
    v_max_f32 v125, v125, v103
    v_max_f32 v126, v126, v111
    v_max_f32 v127, v127, v119
    v_mov_b64 v[132:133], v[124:125]
    v_mov_b64 v[134:135], v[126:127]
    s_nop 0
    v_permlane16_swap_b32 v124, v132
    v_permlane16_swap_b32 v125, v133
    v_permlane16_swap_b32 v126, v134
    v_permlane16_swap_b32 v127, v135
    v_max_f32 v124, v124, v132
    v_max_f32 v125, v125, v133
    v_max_f32 v126, v126, v134
    v_max_f32 v127, v127, v135
    v_mov_b64 v[132:133], v[124:125]
    v_mov_b64 v[134:135], v[126:127]
    s_nop 0
    v_permlane32_swap_b32 v124, v132
    v_permlane32_swap_b32 v125, v133
    v_permlane32_swap_b32 v126, v134
    v_permlane32_swap_b32 v127, v135
    v_max_f32 v124, v124, v132
    v_max_f32 v125, v125, v133
    v_max_f32 v126, v126, v134
    v_max_f32 v127, v127, v135
    v_pk_add_f32 v[92:93], v[92:93], v[124:125] op_sel:[0,0] op_sel_hi:[1,0] neg_lo:[0,1] neg_hi:[0,1]
    v_pk_add_f32 v[94:95], v[94:95], v[124:125] op_sel:[0,0] op_sel_hi:[1,0] neg_lo:[0,1] neg_hi:[0,1]
    v_pk_add_f32 v[100:101], v[100:101], v[124:125] op_sel:[0,1] op_sel_hi:[1,1] neg_lo:[0,1] neg_hi:[0,1]
    v_pk_add_f32 v[102:103], v[102:103], v[124:125] op_sel:[0,1] op_sel_hi:[1,1] neg_lo:[0,1] neg_hi:[0,1]
    v_pk_add_f32 v[108:109], v[108:109], v[126:127] op_sel:[0,0] op_sel_hi:[1,0] neg_lo:[0,1] neg_hi:[0,1]
    v_pk_add_f32 v[110:111], v[110:111], v[126:127] op_sel:[0,0] op_sel_hi:[1,0] neg_lo:[0,1] neg_hi:[0,1]
    v_pk_add_f32 v[116:117], v[116:117], v[126:127] op_sel:[0,1] op_sel_hi:[1,1] neg_lo:[0,1] neg_hi:[0,1]
    v_pk_add_f32 v[118:119], v[118:119], v[126:127] op_sel:[0,1] op_sel_hi:[1,1] neg_lo:[0,1] neg_hi:[0,1]
    v_exp_f32 v92, v92
    v_exp_f32 v93, v93
    v_exp_f32 v94, v94
    v_exp_f32 v95, v95
    v_exp_f32 v100, v100
    v_exp_f32 v101, v101
    v_exp_f32 v102, v102
    v_exp_f32 v103, v103
    v_exp_f32 v108, v108
    v_exp_f32 v109, v109
    v_exp_f32 v110, v110
    v_exp_f32 v111, v111
    v_exp_f32 v116, v116
    v_exp_f32 v117, v117
    v_exp_f32 v118, v118
    v_exp_f32 v119, v119
    v_pk_add_f32 v[96:97], v[92:93], v[94:95]
    v_pk_add_f32 v[104:105], v[100:101], v[102:103]
    v_pk_add_f32 v[112:113], v[108:109], v[110:111]
    v_pk_add_f32 v[120:121], v[116:117], v[118:119]
    v_add_f32 v128, v96, v97
    v_add_f32 v129, v104, v105
    v_add_f32 v130, v112, v113
    v_add_f32 v131, v120, v121
    v_mov_b64 v[132:133], v[128:129]
    v_mov_b64 v[134:135], v[130:131]
    s_nop 0
    v_permlane16_swap_b32 v128, v132
    v_permlane16_swap_b32 v129, v133
    v_permlane16_swap_b32 v130, v134
    v_permlane16_swap_b32 v131, v135
    v_pk_add_f32 v[128:129], v[128:129], v[132:133]
    v_pk_add_f32 v[130:131], v[130:131], v[134:135]
    v_mov_b64 v[132:133], v[128:129]
    v_mov_b64 v[134:135], v[130:131]
    s_nop 0
    v_permlane32_swap_b32 v128, v132
    v_permlane32_swap_b32 v129, v133
    v_permlane32_swap_b32 v130, v134
    v_permlane32_swap_b32 v131, v135
    v_pk_add_f32 v[128:129], v[128:129], v[132:133]
    v_pk_add_f32 v[130:131], v[130:131], v[134:135]
    v_rcp_f32 v128, v128
    v_rcp_f32 v129, v129
    v_rcp_f32 v130, v130
    v_rcp_f32 v131, v131
    v_cndmask_b32 v136, v128, 0, s[74:75]
    v_cndmask_b32 v137, v129, 0, s[74:75]
    v_cndmask_b32 v138, v130, 0, s[74:75]
    v_cndmask_b32 v139, v131, 0, s[74:75]
    v_cndmask_b32 v140, 0, v128, s[74:75]
    v_cndmask_b32 v141, 0, v129, s[74:75]
    v_cndmask_b32 v142, 0, v130, s[74:75]
    v_cndmask_b32 v143, 0, v131, s[74:75]
    v_pk_mul_f32 v[96:97], v[92:93], v[140:141] op_sel:[0,0] op_sel_hi:[1,0]
    v_pk_mul_f32 v[98:99], v[94:95], v[140:141] op_sel:[0,0] op_sel_hi:[1,0]
    v_pk_mul_f32 v[92:93], v[92:93], v[136:137] op_sel:[0,0] op_sel_hi:[1,0]
    v_pk_mul_f32 v[94:95], v[94:95], v[136:137] op_sel:[0,0] op_sel_hi:[1,0]
    v_pk_mul_f32 v[104:105], v[100:101], v[140:141] op_sel:[0,1] op_sel_hi:[1,1]
    v_pk_mul_f32 v[106:107], v[102:103], v[140:141] op_sel:[0,1] op_sel_hi:[1,1]
    v_pk_mul_f32 v[100:101], v[100:101], v[136:137] op_sel:[0,1] op_sel_hi:[1,1]
    v_pk_mul_f32 v[102:103], v[102:103], v[136:137] op_sel:[0,1] op_sel_hi:[1,1]
    v_pk_mul_f32 v[112:113], v[108:109], v[142:143] op_sel:[0,0] op_sel_hi:[1,0]
    v_pk_mul_f32 v[114:115], v[110:111], v[142:143] op_sel:[0,0] op_sel_hi:[1,0]
    v_pk_mul_f32 v[108:109], v[108:109], v[138:139] op_sel:[0,0] op_sel_hi:[1,0]
    v_pk_mul_f32 v[110:111], v[110:111], v[138:139] op_sel:[0,0] op_sel_hi:[1,0]
    v_pk_mul_f32 v[120:121], v[116:117], v[142:143] op_sel:[0,1] op_sel_hi:[1,1]
    v_pk_mul_f32 v[122:123], v[118:119], v[142:143] op_sel:[0,1] op_sel_hi:[1,1]
    v_pk_mul_f32 v[116:117], v[116:117], v[138:139] op_sel:[0,1] op_sel_hi:[1,1]
    v_pk_mul_f32 v[118:119], v[118:119], v[138:139] op_sel:[0,1] op_sel_hi:[1,1]
    v_cvt_pk_bf16_f32 v214, v92, v96
    v_cvt_pk_bf16_f32 v215, v93, v97
    v_cvt_pk_bf16_f32 v216, v94, v98
    v_cvt_pk_bf16_f32 v217, v95, v99
    v_cvt_pk_bf16_f32 v218, v100, v104
    v_cvt_pk_bf16_f32 v219, v101, v105
    v_cvt_pk_bf16_f32 v220, v102, v106
    v_cvt_pk_bf16_f32 v221, v103, v107
    v_cvt_pk_bf16_f32 v222, v108, v112
    v_cvt_pk_bf16_f32 v223, v109, v113
    v_cvt_pk_bf16_f32 v224, v110, v114
    v_cvt_pk_bf16_f32 v225, v111, v115
    v_cvt_pk_bf16_f32 v226, v116, v120
    v_cvt_pk_bf16_f32 v227, v117, v121
    v_cvt_pk_bf16_f32 v228, v118, v122
    v_cvt_pk_bf16_f32 v229, v119, v123
    s_waitcnt lgkmcnt(0)
    v_mfma_f32_16x16x32_bf16 v[92:95], v[72:75], v[214:217], 0
    v_mfma_f32_16x16x32_bf16 v[100:103], v[74:77], v[218:221], 0
    v_mfma_f32_16x16x32_bf16 v[108:111], v[76:79], v[222:225], 0
    v_mfma_f32_16x16x32_bf16 v[116:119], v[78:81], v[226:229], 0
    v_mfma_f32_16x16x32_bf16 v[96:99], v[82:85], v[214:217], 0
    v_mfma_f32_16x16x32_bf16 v[104:107], v[84:87], v[218:221], 0
    v_mfma_f32_16x16x32_bf16 v[112:115], v[86:89], v[222:225], 0
    v_mfma_f32_16x16x32_bf16 v[120:123], v[88:91], v[226:229], 0
    s_add_u32 s63, s22, 40960
    v_cvt_pk_bf16_f32 v232, v92, v93
    v_cvt_pk_bf16_f32 v233, v94, v95
    v_cvt_pk_bf16_f32 v234, v100, v101
    v_cvt_pk_bf16_f32 v235, v102, v103
    v_cvt_pk_bf16_f32 v236, v108, v109
    v_cvt_pk_bf16_f32 v237, v110, v111
    v_cvt_pk_bf16_f32 v238, v116, v117
    v_cvt_pk_bf16_f32 v239, v118, v119
    v_cvt_pk_bf16_f32 v206, v96, v97
    v_cvt_pk_bf16_f32 v207, v98, v99
    v_cvt_pk_bf16_f32 v208, v104, v105
    v_cvt_pk_bf16_f32 v209, v106, v107
    v_cvt_pk_bf16_f32 v210, v112, v113
    v_cvt_pk_bf16_f32 v211, v114, v115
    v_cvt_pk_bf16_f32 v212, v120, v121
    v_cvt_pk_bf16_f32 v213, v122, v123
    v_permlane16_swap_b32 v232, v234
    v_permlane16_swap_b32 v233, v235
    v_permlane16_swap_b32 v236, v238
    v_permlane16_swap_b32 v237, v239
    buffer_store_dwordx4 v[232:235], v22, s[52:55], s22 offen sc1
    buffer_store_dwordx4 v[236:239], v22, s[52:55], s63 offen sc1
    v_cmp_eq_u32 vcc, 1, v2
    s_nop 1
    v_cndmask_b32 v206, v206, v208, vcc
    v_cndmask_b32 v207, v207, v209, vcc
    v_cmp_eq_u32 vcc, 2, v2
    s_nop 1
    v_cndmask_b32 v206, v206, v210, vcc
    v_cndmask_b32 v207, v207, v211, vcc
    v_cmp_eq_u32 vcc, 3, v2
    s_nop 1
    v_cndmask_b32 v206, v206, v212, vcc
    v_cndmask_b32 v207, v207, v213, vcc
    buffer_store_dwordx2 v[206:207], v23, s[52:55], s23 offen sc1
    s_lshl_b32 s69, s6, 2
    s_add_u32 s69, s69, s56
    s_mul_i32 s69, s69, 20480
    s_mul_i32 s64, s7, 160
    s_add_u32 s69, s69, s64
    v_mul_u32_u24 v29, 1280, v1
    s_movk_i32 s64, 40
    v_mad_u32_u24 v29, v2, s64, v29
    buffer_load_dwordx4 v[120:123], v29, s[24:27], s69 offen
    buffer_load_dwordx4 v[124:127], v29, s[24:27], s69 offen offset:16
    buffer_load_dwordx2 v[128:129], v29, s[24:27], s69 offen offset:32
    s_mul_i32 s66, s56, 25600
    v_lshrrev_b32 v4, 1, v2
    v_mul_u32_u24 v4, 20, v4
    v_and_b32 v5, 1, v2
    v_lshl_add_u32 v4, v5, 3, v4
    v_lshrrev_b32 v5, 2, v1
    v_add_u32 v4, v4, v5
    v_mul_u32_u24 v4, 160, v4
    v_and_b32 v6, 3, v0
    v_mul_u32_u24 v6, 40, v6
    v_add3_u32 v27, v4, v6, s66
    v_mul_u32_u24 v4, 40, v2
    v_add_u32 v4, v4, v5
    v_mul_u32_u24 v4, 160, v4
    v_add3_u32 v28, v4, v6, s66
    v_lshlrev_b32 v26, 3, v1
    v_lshl_add_u32 v26, v2, 8, v26
    v_add_u32 v26, 4096, v26
    s_add_u32 s64, s56, 0
    s_and_b32 s64, s64, 3
    s_lshl_b32 s65, s6, 2
    s_add_u32 s64, s64, s65
    s_mul_i32 s64, s64, 80
    s_mul_i32 s65, s56, 20
    s_add_u32 s64, s64, s65
    s_lshl_b32 s64, s64, 8
    s_add_u32 s74, s64, 6291456
    s_add_u32 s64, s56, 1
    s_and_b32 s64, s64, 3
    s_lshl_b32 s65, s6, 2
    s_add_u32 s64, s64, s65
    s_mul_i32 s64, s64, 80
    s_mul_i32 s65, s56, 20
    s_add_u32 s64, s64, s65
    s_lshl_b32 s64, s64, 8
    s_add_u32 s75, s64, 6291456
    s_add_u32 s64, s56, 2
    s_and_b32 s64, s64, 3
    s_lshl_b32 s65, s6, 2
    s_add_u32 s64, s64, s65
    s_mul_i32 s64, s64, 80
    s_mul_i32 s65, s56, 20
    s_add_u32 s64, s64, s65
    s_lshl_b32 s64, s64, 8
    s_add_u32 s76, s64, 6291456
    s_add_u32 s64, s56, 3
    s_and_b32 s64, s64, 3
    s_lshl_b32 s65, s6, 2
    s_add_u32 s64, s64, s65
    s_mul_i32 s64, s64, 80
    s_mul_i32 s65, s56, 20
    s_add_u32 s64, s64, s65
    s_lshl_b32 s64, s64, 8
    s_add_u32 s77, s64, 6291456
    s_lshl_b32 s67, s6, 2
    s_add_u32 s67, s67, s56
    s_mul_i32 s67, s67, 80
    s_lshr_b32 s64, s7, 1
    s_mul_i32 s64, s64, 20
    s_add_u32 s67, s67, s64
    s_and_b32 s64, s7, 1
    s_lshl_b32 s68, s64, 1
    s_add_u32 s68, s68, s67
    s_lshl_b32 s68, s68, 8
    s_add_u32 s68, s68, 8916992
    s_lshl_b32 s64, s64, 3
    s_add_u32 s67, s67, s64
    s_lshl_b32 s67, s67, 8
    s_add_u32 s67, s67, 8912896
    v_lshlrev_b32 v30, 4, v1
    v_lshrrev_b32 v4, 1, v2
    v_lshl_add_u32 v31, v4, 8, v30
    v_and_b32 v4, 1, v2
    v_lshl_add_u32 v31, v4, 3, v31
    v_lshl_add_u32 v30, v2, 9, v30
    s_lshl_b32 s69, s6, 1
    s_lshr_b32 s65, s56, 1
    s_add_u32 s69, s69, s65
    s_lshl_b32 s69, s69, 3
    s_add_u32 s69, s69, s7
    s_lshl_b32 s69, s69, 8
    s_and_b32 s65, s56, 1
    s_lshl_b32 s65, s65, 7
    s_add_u32 s69, s69, s65
    s_add_u32 s69, s69, 11534336
    v_lshlrev_b32 v29, 3, v1
    s_mul_i32 s10, s9, 245760
    s_mul_i32 s11, s56, 6144
    s_add_u32 s10, s10, s11
    s_add_u32 s10, s10, 0
    s_mul_i32 s3, s7, 240
    s_mul_i32 s64, s56, 60
    s_add_u32 s3, s3, s64
    s_lshl_b32 s3, s3, 10
    s_add_u32 s3, s3, 3932160
    s_mov_b32 s73, 18939904
    s_lshl_b32 s70, s6, 9
    s_add_u32 s70, s70, 18874368
    s_mul_i32 s72, s9, 768
    s_add_u32 s72, s72, 5898240
    s_add_u32 s64, s56, 0
    s_and_b32 s64, s64, 3
    s_mul_i32 s64, s64, 15360
    s_add_u32 s64, s64, 98304
    v_add_u32 v36, s64, v3
    s_add_u32 s64, s56, 1
    s_and_b32 s64, s64, 3
    s_mul_i32 s64, s64, 15360
    s_add_u32 s64, s64, 98304
    v_add_u32 v37, s64, v3
    s_add_u32 s64, s56, 2
    s_and_b32 s64, s64, 3
    s_mul_i32 s64, s64, 15360
    s_add_u32 s64, s64, 103424
    v_add_u32 v38, s64, v3
    s_add_u32 s64, s56, 3
    s_and_b32 s64, s64, 3
    s_mul_i32 s64, s64, 15360
    s_add_u32 s64, s64, 108544
    v_add_u32 v39, s64, v3
    s_waitcnt vmcnt(3)
    s_barrier
    s_cmp_lg_u32 s56, 0
    s_cbranch_scc1 L_pub_p1
    s_mul_i32 s60, s57, 8
    s_add_u32 s60, s60, s58
    s_lshl_b32 s60, s60, 6
    s_add_u32 s60, s60, 18874368
    v_mov_b32 v8, s4
    v_mov_b32 v9, s5
    v_lshlrev_b32 v10, 3, v0
    s_mov_b64 exec, 0xff
    buffer_store_dwordx2 v[8:9], v10, s[52:55], s60 offen sc1
    s_mov_b64 exec, -1
L_pub_p1:
    s_getpc_b64 s[60:61]
L_pc2:
    s_lshr_b32 s62, s2, 3
    s_lshl_b32 s62, s62, 2
    s_add_u32 s62, s62, s56
    s_lshl_b32 s62, s62, 8
    v_lshl_add_u32 v4, v0, 2, s62
    v_min_u32 v4, L_exit-L_pc2, v4
    v_mov_b32 v6, s61
    v_add_co_u32 v4, vcc, s60, v4
    s_nop 1
    v_addc_co_u32 v5, vcc, 0, v6, vcc
    global_load_dword v11, v[4:5], off
    ds_read_b64_tr_b16 a[0:1], v27 offset:0
    ds_read_b64_tr_b16 a[2:3], v27 offset:640
    ds_read_b64_tr_b16 a[4:5], v27 offset:8
    ds_read_b64_tr_b16 a[6:7], v27 offset:648
    ds_read_b64_tr_b16 a[8:9], v27 offset:16
    ds_read_b64_tr_b16 a[10:11], v27 offset:656
    ds_read_b64_tr_b16 a[12:13], v27 offset:24
    ds_read_b64_tr_b16 a[14:15], v27 offset:664
    ds_read_b64_tr_b16 a[16:17], v27 offset:32
    ds_read_b64_tr_b16 a[18:19], v27 offset:672
    ds_read_b64_tr_b16 a[20:21], v27 offset:6400
    ds_read_b64_tr_b16 a[22:23], v27 offset:7040
    ds_read_b64_tr_b16 a[24:25], v27 offset:6408
    ds_read_b64_tr_b16 a[26:27], v27 offset:7048
    ds_read_b64_tr_b16 a[28:29], v27 offset:6416
    ds_read_b64_tr_b16 a[30:31], v27 offset:7056
    ds_read_b64_tr_b16 a[32:33], v27 offset:6424
    ds_read_b64_tr_b16 a[34:35], v27 offset:7064
    ds_read_b64_tr_b16 a[36:37], v27 offset:6432
    ds_read_b64_tr_b16 a[38:39], v27 offset:7072
    ds_read_b64_tr_b16 a[40:41], v27 offset:12800
    ds_read_b64_tr_b16 a[42:43], v27 offset:13440
    ds_read_b64_tr_b16 a[44:45], v27 offset:12808
    ds_read_b64_tr_b16 a[46:47], v27 offset:13448
    ds_read_b64_tr_b16 a[48:49], v27 offset:12816
    ds_read_b64_tr_b16 a[50:51], v27 offset:13456
    ds_read_b64_tr_b16 a[52:53], v27 offset:12824
    ds_read_b64_tr_b16 a[54:55], v27 offset:13464
    ds_read_b64_tr_b16 a[56:57], v27 offset:12832
    ds_read_b64_tr_b16 a[58:59], v27 offset:13472
    ds_read_b64_tr_b16 a[60:61], v27 offset:19200
    ds_read_b64_tr_b16 a[62:63], v27 offset:19840
    ds_read_b64_tr_b16 a[64:65], v27 offset:19208
    ds_read_b64_tr_b16 a[66:67], v27 offset:19848
    ds_read_b64_tr_b16 a[68:69], v27 offset:19216
    ds_read_b64_tr_b16 a[70:71], v27 offset:19856
    ds_read_b64_tr_b16 a[72:73], v27 offset:19224
    ds_read_b64_tr_b16 a[74:75], v27 offset:19864
    ds_read_b64_tr_b16 a[76:77], v27 offset:19232
    ds_read_b64_tr_b16 a[78:79], v27 offset:19872
    ds_read_b64_tr_b16 a[80:81], v28 offset:2560
    ds_read_b64_tr_b16 a[82:83], v28 offset:5760
    ds_read_b64_tr_b16 a[84:85], v28 offset:2568
    ds_read_b64_tr_b16 a[86:87], v28 offset:5768
    ds_read_b64_tr_b16 a[88:89], v28 offset:2576
    ds_read_b64_tr_b16 a[90:91], v28 offset:5776
    ds_read_b64_tr_b16 a[92:93], v28 offset:2584
    ds_read_b64_tr_b16 a[94:95], v28 offset:5784
    ds_read_b64_tr_b16 a[96:97], v28 offset:2592
    ds_read_b64_tr_b16 a[98:99], v28 offset:5792
    s_cmp_lg_u32 s56, 3
    s_cbranch_scc1 L_p2_no0
    s_mov_b32 s60, 0
L_poll_p0:
    buffer_load_dwordx4 v[8:11], v3, s[52:55], s73 offen sc1
    buffer_load_dwordx4 v[12:15], v3, s[52:55], s73 offen offset:1024 sc1
    s_waitcnt vmcnt(0)
    v_cmp_ne_u64 vcc, s[4:5], v[8:9]
    v_cmp_ne_u64 s[62:63], s[4:5], v[10:11]
    s_nop 0
    s_or_b64 vcc, vcc, s[62:63]
    v_cmp_ne_u64 s[62:63], s[4:5], v[12:13]
    s_nop 0
    s_or_b64 vcc, vcc, s[62:63]
    v_cmp_ne_u64 s[62:63], s[4:5], v[14:15]
    s_nop 0
    s_or_b64 vcc, vcc, s[62:63]
    s_cmp_eq_u64 vcc, 0
    s_cbranch_scc1 L_polled_p0
    s_add_u32 s60, s60, 1
    s_cmp_lt_u32 s60, 0x10000
    s_cbranch_scc1 L_poll_p0
L_polled_p0:
L_p2_no0:
    s_waitcnt vmcnt(0)
    v_lshlrev_b32 v40, 16, v120
    v_and_b32 v41, 0xffff0000, v120
    v_lshlrev_b32 v42, 16, v121
    v_and_b32 v43, 0xffff0000, v121
    v_lshlrev_b32 v44, 16, v122
    v_and_b32 v45, 0xffff0000, v122
    v_lshlrev_b32 v46, 16, v123
    v_and_b32 v47, 0xffff0000, v123
    v_lshlrev_b32 v48, 16, v124
    v_and_b32 v49, 0xffff0000, v124
    v_lshlrev_b32 v50, 16, v125
    v_and_b32 v51, 0xffff0000, v125
    v_lshlrev_b32 v52, 16, v126
    v_and_b32 v53, 0xffff0000, v126
    v_lshlrev_b32 v54, 16, v127
    v_and_b32 v55, 0xffff0000, v127
    v_lshlrev_b32 v56, 16, v128
    v_and_b32 v57, 0xffff0000, v128
    v_lshlrev_b32 v58, 16, v129
    v_and_b32 v59, 0xffff0000, v129
    s_waitcnt lgkmcnt(0)
    s_barrier
    s_cmp_lg_u32 s56, 1
    s_cbranch_scc1 L_polled_p2
    s_mov_b32 s60, 0
    v_and_b32 v4, 7, v0
    v_lshlrev_b32 v4, 6, v4
L_poll_p2:
    buffer_load_dwordx2 v[8:9], v4, s[52:55], s70 offen sc1
    s_waitcnt vmcnt(0)
    v_cmp_ne_u64 vcc, s[4:5], v[8:9]
    s_nop 0
    s_cmp_eq_u64 vcc, 0
    s_cbranch_scc1 L_polled_p2
    s_add_u32 s60, s60, 1
    s_cmp_lt_u32 s60, 0x10000
    s_cbranch_scc1 L_poll_p2
L_polled_p2:
    s_waitcnt vmcnt(0)
    s_barrier
    s_mul_i32 s65, s6, 81920
    s_add_u32 s65, s65, 6291456
    buffer_load_dwordx4 a[100:103], v3, s[52:55], s74 offen offset:0 sc1
    buffer_load_dwordx4 a[120:123], v3, s[52:55], s75 offen offset:0 sc1
    buffer_load_dwordx4 a[140:143], v3, s[52:55], s76 offen offset:0 sc1
    buffer_load_dwordx4 a[160:163], v3, s[52:55], s77 offen offset:0 sc1
    buffer_load_dwordx4 a[104:107], v3, s[52:55], s74 offen offset:1024 sc1
    buffer_load_dwordx4 a[124:127], v3, s[52:55], s75 offen offset:1024 sc1
    buffer_load_dwordx4 a[144:147], v3, s[52:55], s76 offen offset:1024 sc1
    buffer_load_dwordx4 a[164:167], v3, s[52:55], s77 offen offset:1024 sc1
    buffer_load_dwordx4 a[108:111], v3, s[52:55], s74 offen offset:2048 sc1
    buffer_load_dwordx4 a[128:131], v3, s[52:55], s75 offen offset:2048 sc1
    buffer_load_dwordx4 a[148:151], v3, s[52:55], s76 offen offset:2048 sc1
    buffer_load_dwordx4 a[168:171], v3, s[52:55], s77 offen offset:2048 sc1
    buffer_load_dwordx4 a[112:115], v3, s[52:55], s74 offen offset:3072 sc1
    buffer_load_dwordx4 a[132:135], v3, s[52:55], s75 offen offset:3072 sc1
    buffer_load_dwordx4 a[152:155], v3, s[52:55], s76 offen offset:3072 sc1
    buffer_load_dwordx4 a[172:175], v3, s[52:55], s77 offen offset:3072 sc1
    buffer_load_dwordx2 a[116:117], v26, s[52:55], s74 offen offset:0 sc1
    buffer_load_dwordx2 a[118:119], v26, s[52:55], s74 offen offset:128 sc1
    buffer_load_dwordx2 a[136:137], v26, s[52:55], s75 offen offset:0 sc1
    buffer_load_dwordx2 a[138:139], v26, s[52:55], s75 offen offset:128 sc1
    buffer_load_dwordx2 a[156:157], v26, s[52:55], s76 offen offset:0 sc1
    buffer_load_dwordx2 a[158:159], v26, s[52:55], s76 offen offset:128 sc1
    buffer_load_dwordx2 a[176:177], v26, s[52:55], s77 offen offset:0 sc1
    buffer_load_dwordx2 a[178:179], v26, s[52:55], s77 offen offset:128 sc1
    s_mul_i32 s65, s9, 245760
    s_add_u32 s65, s65, 0
    s_waitcnt vmcnt(20)
    v_mfma_f32_16x16x32_bf16 v[40:43], a[0:3], a[100:103], v[40:43]
    v_mfma_f32_16x16x32_bf16 v[60:63], a[0:3], a[120:123], 0
    v_mfma_f32_16x16x32_bf16 v[80:83], a[0:3], a[140:143], 0
    v_mfma_f32_16x16x32_bf16 v[100:103], a[0:3], a[160:163], 0
    v_mfma_f32_16x16x32_bf16 v[44:47], a[4:7], a[100:103], v[44:47]
    v_mfma_f32_16x16x32_bf16 v[64:67], a[4:7], a[120:123], 0
    v_mfma_f32_16x16x32_bf16 v[84:87], a[4:7], a[140:143], 0
    v_mfma_f32_16x16x32_bf16 v[104:107], a[4:7], a[160:163], 0
    v_mfma_f32_16x16x32_bf16 v[48:51], a[8:11], a[100:103], v[48:51]
    v_mfma_f32_16x16x32_bf16 v[68:71], a[8:11], a[120:123], 0
    v_mfma_f32_16x16x32_bf16 v[88:91], a[8:11], a[140:143], 0
    v_mfma_f32_16x16x32_bf16 v[108:111], a[8:11], a[160:163], 0
    v_mfma_f32_16x16x32_bf16 v[52:55], a[12:15], a[100:103], v[52:55]
    v_mfma_f32_16x16x32_bf16 v[72:75], a[12:15], a[120:123], 0
    v_mfma_f32_16x16x32_bf16 v[92:95], a[12:15], a[140:143], 0
    v_mfma_f32_16x16x32_bf16 v[112:115], a[12:15], a[160:163], 0
    v_mfma_f32_16x16x32_bf16 v[56:59], a[16:19], a[100:103], v[56:59]
    v_mfma_f32_16x16x32_bf16 v[76:79], a[16:19], a[120:123], 0
    v_mfma_f32_16x16x32_bf16 v[96:99], a[16:19], a[140:143], 0
    v_mfma_f32_16x16x32_bf16 v[116:119], a[16:19], a[160:163], 0
    s_waitcnt vmcnt(16)
    v_mfma_f32_16x16x32_bf16 v[40:43], a[20:23], a[104:107], v[40:43]
    v_mfma_f32_16x16x32_bf16 v[60:63], a[20:23], a[124:127], v[60:63]
    v_mfma_f32_16x16x32_bf16 v[80:83], a[20:23], a[144:147], v[80:83]
    v_mfma_f32_16x16x32_bf16 v[100:103], a[20:23], a[164:167], v[100:103]
    v_mfma_f32_16x16x32_bf16 v[44:47], a[24:27], a[104:107], v[44:47]
    v_mfma_f32_16x16x32_bf16 v[64:67], a[24:27], a[124:127], v[64:67]
    v_mfma_f32_16x16x32_bf16 v[84:87], a[24:27], a[144:147], v[84:87]
    v_mfma_f32_16x16x32_bf16 v[104:107], a[24:27], a[164:167], v[104:107]
    s_add_u32 m0, s11, 0
    s_add_u32 s71, s10, 0
    buffer_load_dwordx4 v3, s[52:55], s71 offen offset:0 sc1 lds
    v_mfma_f32_16x16x32_bf16 v[48:51], a[28:31], a[104:107], v[48:51]
    v_mfma_f32_16x16x32_bf16 v[68:71], a[28:31], a[124:127], v[68:71]
    v_mfma_f32_16x16x32_bf16 v[88:91], a[28:31], a[144:147], v[88:91]
    buffer_load_dwordx4 v3, s[52:55], s71 offen offset:1024 sc1 lds
    v_mfma_f32_16x16x32_bf16 v[108:111], a[28:31], a[164:167], v[108:111]
    v_mfma_f32_16x16x32_bf16 v[52:55], a[32:35], a[104:107], v[52:55]
    v_mfma_f32_16x16x32_bf16 v[72:75], a[32:35], a[124:127], v[72:75]
    buffer_load_dwordx4 v3, s[52:55], s71 offen offset:2048 sc1 lds
    v_mfma_f32_16x16x32_bf16 v[92:95], a[32:35], a[144:147], v[92:95]
    v_mfma_f32_16x16x32_bf16 v[112:115], a[32:35], a[164:167], v[112:115]
    v_mfma_f32_16x16x32_bf16 v[56:59], a[36:39], a[104:107], v[56:59]
    buffer_load_dwordx4 v3, s[52:55], s71 offen offset:3072 sc1 lds
    v_mfma_f32_16x16x32_bf16 v[76:79], a[36:39], a[124:127], v[76:79]
    v_mfma_f32_16x16x32_bf16 v[96:99], a[36:39], a[144:147], v[96:99]
    v_mfma_f32_16x16x32_bf16 v[116:119], a[36:39], a[164:167], v[116:119]
    s_add_u32 m0, s11, 4096
    s_add_u32 s71, s10, 4096
    buffer_load_dwordx4 v3, s[52:55], s71 offen offset:0 sc1 lds
    s_waitcnt vmcnt(17)
    v_mfma_f32_16x16x32_bf16 v[40:43], a[40:43], a[108:111], v[40:43]
    v_mfma_f32_16x16x32_bf16 v[60:63], a[40:43], a[128:131], v[60:63]
    v_mfma_f32_16x16x32_bf16 v[80:83], a[40:43], a[148:151], v[80:83]
    buffer_load_dwordx4 v3, s[52:55], s71 offen offset:1024 sc1 lds
    v_mfma_f32_16x16x32_bf16 v[100:103], a[40:43], a[168:171], v[100:103]
    v_mfma_f32_16x16x32_bf16 v[44:47], a[44:47], a[108:111], v[44:47]
    v_mfma_f32_16x16x32_bf16 v[64:67], a[44:47], a[128:131], v[64:67]
    s_add_u32 m0, s11, 24576
    s_add_u32 s71, s10, 24576
    buffer_load_dwordx4 v3, s[52:55], s71 offen offset:0 sc1 lds
    v_mfma_f32_16x16x32_bf16 v[84:87], a[44:47], a[148:151], v[84:87]
    v_mfma_f32_16x16x32_bf16 v[104:107], a[44:47], a[168:171], v[104:107]
    v_mfma_f32_16x16x32_bf16 v[48:51], a[48:51], a[108:111], v[48:51]
    buffer_load_dwordx4 v3, s[52:55], s71 offen offset:1024 sc1 lds
    v_mfma_f32_16x16x32_bf16 v[68:71], a[48:51], a[128:131], v[68:71]
    v_mfma_f32_16x16x32_bf16 v[88:91], a[48:51], a[148:151], v[88:91]
    v_mfma_f32_16x16x32_bf16 v[108:111], a[48:51], a[168:171], v[108:111]
    buffer_load_dwordx4 v3, s[52:55], s71 offen offset:2048 sc1 lds
    v_mfma_f32_16x16x32_bf16 v[52:55], a[52:55], a[108:111], v[52:55]
    v_mfma_f32_16x16x32_bf16 v[72:75], a[52:55], a[128:131], v[72:75]
    v_mfma_f32_16x16x32_bf16 v[92:95], a[52:55], a[148:151], v[92:95]
    buffer_load_dwordx4 v3, s[52:55], s71 offen offset:3072 sc1 lds
    v_mfma_f32_16x16x32_bf16 v[112:115], a[52:55], a[168:171], v[112:115]
    v_mfma_f32_16x16x32_bf16 v[56:59], a[56:59], a[108:111], v[56:59]
    v_mfma_f32_16x16x32_bf16 v[76:79], a[56:59], a[128:131], v[76:79]
    s_add_u32 m0, s11, 28672
    s_add_u32 s71, s10, 28672
    buffer_load_dwordx4 v3, s[52:55], s71 offen offset:0 sc1 lds
    v_mfma_f32_16x16x32_bf16 v[96:99], a[56:59], a[148:151], v[96:99]
    v_mfma_f32_16x16x32_bf16 v[116:119], a[56:59], a[168:171], v[116:119]
    s_waitcnt vmcnt(19)
    v_mfma_f32_16x16x32_bf16 v[60:63], a[60:63], a[132:135], v[60:63]
    buffer_load_dwordx4 v3, s[52:55], s71 offen offset:1024 sc1 lds
    v_mfma_f32_16x16x32_bf16 v[64:67], a[64:67], a[132:135], v[64:67]
    v_mfma_f32_16x16x32_bf16 v[68:71], a[68:71], a[132:135], v[68:71]
    v_mfma_f32_16x16x32_bf16 v[72:75], a[72:75], a[132:135], v[72:75]
    s_add_u32 m0, s11, 49152
    s_add_u32 s71, s10, 49152
    buffer_load_dwordx4 v3, s[52:55], s71 offen offset:0 sc1 lds
    v_mfma_f32_16x16x32_bf16 v[76:79], a[76:79], a[132:135], v[76:79]
    s_waitcnt vmcnt(13)
    v_mfma_f32_16x16x32_bf16 v[60:63], a[80:83], a[136:139], v[60:63]
    v_mfma_f32_16x16x32_bf16 v[64:67], a[84:87], a[136:139], v[64:67]
    buffer_load_dwordx4 v3, s[52:55], s71 offen offset:1024 sc1 lds
    v_mfma_f32_16x16x32_bf16 v[68:71], a[88:91], a[136:139], v[68:71]
    v_mfma_f32_16x16x32_bf16 v[72:75], a[92:95], a[136:139], v[72:75]
    v_mfma_f32_16x16x32_bf16 v[76:79], a[96:99], a[136:139], v[76:79]
    buffer_load_dwordx4 v3, s[52:55], s71 offen offset:2048 sc1 lds
    v_mfma_f32_16x16x32_bf16 v[80:83], a[60:63], a[152:155], v[80:83]
    v_mfma_f32_16x16x32_bf16 v[84:87], a[64:67], a[152:155], v[84:87]
    v_mfma_f32_16x16x32_bf16 v[88:91], a[68:71], a[152:155], v[88:91]
    buffer_load_dwordx4 v3, s[52:55], s71 offen offset:3072 sc1 lds
    v_mfma_f32_16x16x32_bf16 v[92:95], a[72:75], a[152:155], v[92:95]
    v_mfma_f32_16x16x32_bf16 v[96:99], a[76:79], a[152:155], v[96:99]
    ds_write_b128 v37, v[60:63] offset:0
    v_mfma_f32_16x16x32_bf16 v[80:83], a[80:83], a[156:159], v[80:83]
    s_add_u32 m0, s11, 53248
    s_add_u32 s71, s10, 53248
    buffer_load_dwordx4 v3, s[52:55], s71 offen offset:0 sc1 lds
    v_mfma_f32_16x16x32_bf16 v[84:87], a[84:87], a[156:159], v[84:87]
    ds_write_b128 v37, v[64:67] offset:1024
    v_mfma_f32_16x16x32_bf16 v[88:91], a[88:91], a[156:159], v[88:91]
    v_mfma_f32_16x16x32_bf16 v[92:95], a[92:95], a[156:159], v[92:95]
    ds_write_b128 v37, v[68:71] offset:2048
    v_mfma_f32_16x16x32_bf16 v[96:99], a[96:99], a[156:159], v[96:99]
    v_mfma_f32_16x16x32_bf16 v[100:103], a[60:63], a[172:175], v[100:103]
    ds_write_b128 v37, v[72:75] offset:3072
    v_mfma_f32_16x16x32_bf16 v[104:107], a[64:67], a[172:175], v[104:107]
    buffer_load_dwordx4 v3, s[52:55], s71 offen offset:1024 sc1 lds
    v_mfma_f32_16x16x32_bf16 v[108:111], a[68:71], a[172:175], v[108:111]
    ds_write_b128 v37, v[76:79] offset:4096
    v_mfma_f32_16x16x32_bf16 v[112:115], a[72:75], a[172:175], v[112:115]
    v_mfma_f32_16x16x32_bf16 v[116:119], a[76:79], a[172:175], v[116:119]
    ds_write_b128 v38, v[80:83] offset:0
    v_mfma_f32_16x16x32_bf16 v[100:103], a[80:83], a[176:179], v[100:103]
    v_mfma_f32_16x16x32_bf16 v[104:107], a[84:87], a[176:179], v[104:107]
    ds_write_b128 v38, v[84:87] offset:1024
    v_mfma_f32_16x16x32_bf16 v[108:111], a[88:91], a[176:179], v[108:111]
    s_add_u32 m0, s11, 73728
    s_add_u32 s71, s10, 73728
    buffer_load_dwordx4 v3, s[52:55], s71 offen offset:0 sc1 lds
    v_mfma_f32_16x16x32_bf16 v[112:115], a[92:95], a[176:179], v[112:115]
    ds_write_b128 v38, v[88:91] offset:2048
    v_mfma_f32_16x16x32_bf16 v[116:119], a[96:99], a[176:179], v[116:119]
    v_mfma_f32_16x16x32_bf16 v[40:43], a[60:63], a[112:115], v[40:43]
    ds_write_b128 v38, v[92:95] offset:3072
    v_mfma_f32_16x16x32_bf16 v[44:47], a[64:67], a[112:115], v[44:47]
    v_mfma_f32_16x16x32_bf16 v[48:51], a[68:71], a[112:115], v[48:51]
    ds_write_b128 v38, v[96:99] offset:4096
    v_mfma_f32_16x16x32_bf16 v[52:55], a[72:75], a[112:115], v[52:55]
    buffer_load_dwordx4 v3, s[52:55], s71 offen offset:1024 sc1 lds
    v_mfma_f32_16x16x32_bf16 v[56:59], a[76:79], a[112:115], v[56:59]
    ds_write_b128 v39, v[100:103] offset:0
    v_mfma_f32_16x16x32_bf16 v[40:43], a[80:83], a[116:119], v[40:43]
    v_mfma_f32_16x16x32_bf16 v[44:47], a[84:87], a[116:119], v[44:47]
    ds_write_b128 v39, v[104:107] offset:1024
    v_mfma_f32_16x16x32_bf16 v[48:51], a[88:91], a[116:119], v[48:51]
    v_mfma_f32_16x16x32_bf16 v[52:55], a[92:95], a[116:119], v[52:55]
    ds_write_b128 v39, v[108:111] offset:2048
    v_mfma_f32_16x16x32_bf16 v[56:59], a[96:99], a[116:119], v[56:59]
    buffer_load_dwordx4 v3, s[52:55], s71 offen offset:2048 sc1 lds
    ds_write_b128 v39, v[112:115] offset:3072
    ds_write_b128 v39, v[116:119] offset:4096
    s_waitcnt lgkmcnt(0)
    s_barrier
    ds_read_b128 v[120:123], v36 offset:0
    ds_read_b128 v[124:127], v36 offset:1024
    ds_read_b128 v[128:131], v36 offset:2048
    ds_read_b128 v[132:135], v36 offset:3072
    ds_read_b128 v[136:139], v36 offset:4096
    ds_read_b128 v[140:143], v36 offset:5120
    ds_read_b128 v[144:147], v36 offset:6144
    ds_read_b128 v[148:151], v36 offset:7168
    ds_read_b128 v[152:155], v36 offset:8192
    ds_read_b128 v[156:159], v36 offset:9216
    ds_read_b128 v[160:163], v36 offset:10240
    ds_read_b128 v[164:167], v36 offset:11264
    ds_read_b128 v[168:171], v36 offset:12288
    ds_read_b128 v[172:175], v36 offset:13312
    ds_read_b128 v[176:179], v36 offset:14336
    buffer_load_dwordx4 v3, s[52:55], s71 offen offset:3072 sc1 lds
    s_add_u32 m0, s11, 77824
    s_add_u32 s71, s10, 77824
    buffer_load_dwordx4 v3, s[52:55], s71 offen offset:0 sc1 lds
    buffer_load_dwordx4 v3, s[52:55], s71 offen offset:1024 sc1 lds
    buffer_load_dwordx4 v[224:227], v3, s[52:55], s72 offen sc1
    s_add_u32 s72, s72, 12288
    buffer_load_dwordx4 v[228:231], v3, s[52:55], s72 offen sc1
    s_add_u32 s72, s72, 12288
    buffer_load_dwordx4 v[232:235], v3, s[52:55], s72 offen sc1
    s_add_u32 s72, s72, 12288
    s_waitcnt lgkmcnt(14)
    v_pk_add_f32 v[40:41], v[40:41], v[120:121]
    v_pk_add_f32 v[42:43], v[42:43], v[122:123]
    s_waitcnt lgkmcnt(13)
    v_pk_add_f32 v[44:45], v[44:45], v[124:125]
    v_pk_add_f32 v[46:47], v[46:47], v[126:127]
    s_waitcnt lgkmcnt(12)
    v_pk_add_f32 v[48:49], v[48:49], v[128:129]
    v_pk_add_f32 v[50:51], v[50:51], v[130:131]
    s_waitcnt lgkmcnt(11)
    v_pk_add_f32 v[52:53], v[52:53], v[132:133]
    v_pk_add_f32 v[54:55], v[54:55], v[134:135]
    s_waitcnt lgkmcnt(10)
    v_pk_add_f32 v[56:57], v[56:57], v[136:137]
    v_pk_add_f32 v[58:59], v[58:59], v[138:139]
    s_waitcnt lgkmcnt(9)
    v_pk_add_f32 v[40:41], v[40:41], v[140:141]
    v_pk_add_f32 v[42:43], v[42:43], v[142:143]
    s_waitcnt lgkmcnt(8)
    v_pk_add_f32 v[44:45], v[44:45], v[144:145]
    v_pk_add_f32 v[46:47], v[46:47], v[146:147]
    s_waitcnt lgkmcnt(7)
    v_pk_add_f32 v[48:49], v[48:49], v[148:149]
    v_pk_add_f32 v[50:51], v[50:51], v[150:151]
    s_waitcnt lgkmcnt(6)
    v_pk_add_f32 v[52:53], v[52:53], v[152:153]
    v_pk_add_f32 v[54:55], v[54:55], v[154:155]
    s_waitcnt lgkmcnt(5)
    v_pk_add_f32 v[56:57], v[56:57], v[156:157]
    v_pk_add_f32 v[58:59], v[58:59], v[158:159]
    s_waitcnt lgkmcnt(4)
    v_pk_add_f32 v[40:41], v[40:41], v[160:161]
    v_pk_add_f32 v[42:43], v[42:43], v[162:163]
    s_waitcnt lgkmcnt(3)
    v_pk_add_f32 v[44:45], v[44:45], v[164:165]
    v_pk_add_f32 v[46:47], v[46:47], v[166:167]
    s_waitcnt lgkmcnt(2)
    v_pk_add_f32 v[48:49], v[48:49], v[168:169]
    v_pk_add_f32 v[50:51], v[50:51], v[170:171]
    s_waitcnt lgkmcnt(1)
    v_pk_add_f32 v[52:53], v[52:53], v[172:173]
    v_pk_add_f32 v[54:55], v[54:55], v[174:175]
    s_waitcnt lgkmcnt(0)
    v_pk_add_f32 v[56:57], v[56:57], v[176:177]
    v_pk_add_f32 v[58:59], v[58:59], v[178:179]
    v_cvt_pk_bf16_f32 v16, v40, v41
    v_cvt_pk_bf16_f32 v17, v42, v43
    v_cvt_pk_bf16_f32 v18, v44, v45
    v_cvt_pk_bf16_f32 v19, v46, v47
    v_cvt_pk_bf16_f32 v20, v48, v49
    v_cvt_pk_bf16_f32 v21, v50, v51
    v_cvt_pk_bf16_f32 v22, v52, v53
    v_cvt_pk_bf16_f32 v23, v54, v55
    v_cvt_pk_bf16_f32 v24, v56, v57
    v_cvt_pk_bf16_f32 v25, v58, v59
    buffer_store_dwordx4 v[16:19], v30, s[52:55], s67 offen sc1
    buffer_store_dwordx4 v[20:23], v30, s[52:55], s67 offen offset:256 sc1
    buffer_store_dwordx2 v[24:25], v31, s[52:55], s68 offen sc1
    v_mov_b32 v32, 0
    v_mov_b32 v33, 0
    v_mov_b32 v4, 0x3f803f80
    v_dot2c_f32_bf16 v32, v16, v4
    v_dot2c_f32_bf16 v33, v16, v16
    v_dot2c_f32_bf16 v32, v17, v4
    v_dot2c_f32_bf16 v33, v17, v17
    v_dot2c_f32_bf16 v32, v18, v4
    v_dot2c_f32_bf16 v33, v18, v18
    v_dot2c_f32_bf16 v32, v19, v4
    v_dot2c_f32_bf16 v33, v19, v19
    v_dot2c_f32_bf16 v32, v20, v4
    v_dot2c_f32_bf16 v33, v20, v20
    v_dot2c_f32_bf16 v32, v21, v4
    v_dot2c_f32_bf16 v33, v21, v21
    v_dot2c_f32_bf16 v32, v22, v4
    v_dot2c_f32_bf16 v33, v22, v22
    v_dot2c_f32_bf16 v32, v23, v4
    v_dot2c_f32_bf16 v33, v23, v23
    v_dot2c_f32_bf16 v32, v24, v4
    v_dot2c_f32_bf16 v33, v24, v24
    v_dot2c_f32_bf16 v32, v25, v4
    v_dot2c_f32_bf16 v33, v25, v25
    s_nop 1
    v_mov_b32 v34, v32
    v_mov_b32 v35, v33
    s_nop 0
    v_permlane16_swap_b32 v32, v34
    v_permlane16_swap_b32 v33, v35
    v_add_f32 v32, v32, v34
    v_add_f32 v33, v33, v35
    v_mov_b32 v34, v32
    v_mov_b32 v35, v33
    s_nop 0
    v_permlane32_swap_b32 v32, v34
    v_permlane32_swap_b32 v33, v35
    v_add_f32 v32, v32, v34
    v_add_f32 v33, v33, v35
    s_mov_b64 exec, 0xffff
    buffer_store_dwordx2 v[32:33], v29, s[52:55], s69 offen sc1
    s_mov_b64 exec, -1
    buffer_load_dwordx4 v[236:239], v3, s[52:55], s72 offen sc1
    s_add_u32 s72, s72, 12288
    buffer_load_dwordx4 v[240:243], v3, s[52:55], s72 offen sc1
    s_add_u32 s72, s72, 12288
    buffer_load_dwordx4 v[244:247], v3, s[52:55], s72 offen sc1
    s_add_u32 s72, s72, 12288
    buffer_load_dwordx4 v[248:251], v3, s[52:55], s72 offen sc1
    s_add_u32 s72, s72, 12288
    buffer_load_dwordx4 v[252:255], v3, s[52:55], s72 offen sc1
    s_add_u32 s72, s72, 12288
    s_add_u32 s59, s3, 0
    buffer_load_dwordx4 a[180:183], v3, s[52:55], s59 offen offset:0 sc1
    buffer_load_dwordx4 a[184:187], v3, s[52:55], s59 offen offset:1024 sc1
    buffer_load_dwordx4 a[188:191], v3, s[52:55], s59 offen offset:2048 sc1
    buffer_load_dwordx4 a[192:195], v3, s[52:55], s59 offen offset:3072 sc1
    s_add_u32 s59, s3, 4096
    buffer_load_dwordx4 a[196:199], v3, s[52:55], s59 offen offset:0 sc1
    s_lshl_b32 s69, s8, 10
    s_add_u32 s69, s69, 18907136
    v_lshlrev_b32 v4, 4, v1
    v_lshrrev_b32 v5, 5, v0
    v_lshl_add_u32 v4, v5, 8, v4
    v_and_b32 v6, 31, v0
    v_lshlrev_b32 v29, 2, v6
    v_add_u32 v29, 159744, v29
    v_lshlrev_b32 v6, 3, v6
    v_lshl_add_u32 v27, v5, 10, v6
    v_and_b32 v5, 1, v2
    s_movk_i32 s64, 20480
    v_mad_u32_u24 v26, v5, s64, v4
    s_mov_b32 s64, 49152
    v_mad_u32_u24 v28, v5, s64, v4
    s_lshl_b32 s64, s8, 2
    s_add_u32 s64, s64, s56
    s_mul_i32 s66, s64, 40960
    s_add_u32 s66, s66, 8912896
    s_mul_i32 s67, s64, 98304
    s_lshr_b32 s65, s9, 2
    s_mul_i32 s65, s65, 12288
    s_add_u32 s67, s67, s65
    s_add_u32 s67, s67, 12582912
    s_and_b32 s65, s9, 3
    s_lshl_b32 s77, s65, 9
    s_add_u32 s77, s77, s67
    s_add_u32 s77, s77, 8192
    s_lshl_b32 s65, s65, 10
    s_add_u32 s67, s67, s65
    s_add_u32 s76, s67, 4096
    s_lshl_b32 s68, s64, 11
    s_add_u32 s68, s68, 11534336
    v_add_u32 v52, 0, v3
    v_add_u32 v53, 49152, v3
    v_add_u32 v54, 98304, v3
    s_waitcnt vmcnt(10)
    s_barrier
    s_cmp_lg_u32 s56, 0
    s_cbranch_scc1 L_pub_p2
    s_mul_i32 s60, s6, 8
    s_add_u32 s60, s60, s7
    s_lshl_b32 s60, s60, 6
    s_add_u32 s60, s60, 18907136
    v_mov_b32 v8, s4
    v_mov_b32 v9, s5
    v_lshlrev_b32 v10, 3, v0
    s_mov_b64 exec, 0xff
    buffer_store_dwordx2 v[8:9], v10, s[52:55], s60 offen sc1
    s_mov_b64 exec, -1
L_pub_p2:
    s_mul_i32 s72, s7, 245760
    s_add_u32 s72, s72, 3932160
    s_add_u32 m0, s11, 98304
    s_add_u32 s71, s10, 98304
    buffer_load_dwordx4 v3, s[52:55], s71 offen offset:0 sc1 lds
    buffer_load_dwordx4 v3, s[52:55], s71 offen offset:1024 sc1 lds
    buffer_load_dwordx4 v3, s[52:55], s71 offen offset:2048 sc1 lds
    buffer_load_dwordx4 v3, s[52:55], s71 offen offset:3072 sc1 lds
    s_add_u32 m0, s11, 102400
    s_add_u32 s71, s10, 102400
    buffer_load_dwordx4 v3, s[52:55], s71 offen offset:0 sc1 lds
    buffer_load_dwordx4 v3, s[52:55], s71 offen offset:1024 sc1 lds
    s_add_u32 m0, s11, 122880
    s_add_u32 s71, s10, 122880
    buffer_load_dwordx4 v3, s[52:55], s71 offen offset:0 sc1 lds
    buffer_load_dwordx4 v3, s[52:55], s71 offen offset:1024 sc1 lds
    buffer_load_dwordx4 v3, s[52:55], s71 offen offset:2048 sc1 lds
    buffer_load_dwordx4 v3, s[52:55], s71 offen offset:3072 sc1 lds
    s_add_u32 m0, s11, 126976
    s_add_u32 s71, s10, 126976
    buffer_load_dwordx4 v3, s[52:55], s71 offen offset:0 sc1 lds
    buffer_load_dwordx4 v3, s[52:55], s71 offen offset:1024 sc1 lds
    s_add_u32 s59, s3, 5120
    buffer_load_dwordx4 a[200:203], v3, s[52:55], s59 offen offset:0 sc1
    buffer_load_dwordx4 a[204:207], v3, s[52:55], s59 offen offset:1024 sc1
    buffer_load_dwordx4 a[208:211], v3, s[52:55], s59 offen offset:2048 sc1
    buffer_load_dwordx4 a[212:215], v3, s[52:55], s59 offen offset:3072 sc1
    s_add_u32 s59, s3, 9216
    buffer_load_dwordx4 a[216:219], v3, s[52:55], s59 offen offset:0 sc1
    s_add_u32 s59, s3, 10240
    buffer_load_dwordx4 a[220:223], v3, s[52:55], s59 offen offset:0 sc1
    buffer_load_dwordx4 a[224:227], v3, s[52:55], s59 offen offset:1024 sc1
    buffer_load_dwordx4 a[228:231], v3, s[52:55], s59 offen offset:2048 sc1
    ds_read_b128 v[120:123], v52 offset:0
    ds_read_b128 v[124:127], v52 offset:1024
    ds_read_b128 v[128:131], v52 offset:2048
    ds_read_b128 v[132:135], v52 offset:3072
    ds_read_b128 v[136:139], v52 offset:4096
    s_cmp_lg_u32 s56, 1
    s_cbranch_scc1 L_polled_p3
    s_mov_b32 s60, 0
    v_and_b32 v4, 15, v0
    v_lshlrev_b32 v4, 6, v4
L_poll_p3:
    buffer_load_dwordx2 v[8:9], v4, s[52:55], s69 offen sc1
    s_waitcnt vmcnt(0)
    v_cmp_ne_u64 vcc, s[4:5], v[8:9]
    s_nop 0
    s_cmp_eq_u64 vcc, 0
    s_cbranch_scc1 L_polled_p3
    s_add_u32 s60, s60, 1
    s_cmp_lt_u32 s60, 0x10000
    s_cbranch_scc1 L_poll_p3
L_polled_p3:
    s_waitcnt vmcnt(0)
    s_barrier
    s_mul_i32 s65, s8, 163840
    s_add_u32 s65, s65, 8912896
    buffer_load_dwordx4 a[0:3], v26, s[52:55], s66 offen offset:0 sc1
    buffer_load_dwordx4 a[4:7], v26, s[52:55], s66 offen offset:512 sc1
    buffer_load_dwordx4 a[8:11], v26, s[52:55], s66 offen offset:1024 sc1
    buffer_load_dwordx4 a[12:15], v26, s[52:55], s66 offen offset:1536 sc1
    buffer_load_dwordx4 a[16:19], v26, s[52:55], s66 offen offset:2048 sc1
    buffer_load_dwordx4 a[20:23], v26, s[52:55], s66 offen offset:2560 sc1
    buffer_load_dwordx4 a[24:27], v26, s[52:55], s66 offen offset:3072 sc1
    buffer_load_dwordx4 a[28:31], v26, s[52:55], s66 offen offset:3584 sc1
    s_add_u32 s66, s66, 4096
    buffer_load_dwordx4 a[32:35], v26, s[52:55], s66 offen offset:0 sc1
    buffer_load_dwordx4 a[36:39], v26, s[52:55], s66 offen offset:512 sc1
    buffer_load_dwordx4 a[40:43], v26, s[52:55], s66 offen offset:1024 sc1
    buffer_load_dwordx4 a[44:47], v26, s[52:55], s66 offen offset:1536 sc1
    buffer_load_dwordx4 a[48:51], v26, s[52:55], s66 offen offset:2048 sc1
    buffer_load_dwordx4 a[52:55], v26, s[52:55], s66 offen offset:2560 sc1
    buffer_load_dwordx4 a[56:59], v26, s[52:55], s66 offen offset:3072 sc1
    buffer_load_dwordx4 a[60:63], v26, s[52:55], s66 offen offset:3584 sc1
    v_pk_add_f32 v[224:225], v[224:225], v[228:229]
    v_pk_add_f32 v[226:227], v[226:227], v[230:231]
    v_pk_add_f32 v[224:225], v[224:225], v[232:233]
    v_pk_add_f32 v[226:227], v[226:227], v[234:235]
    v_pk_add_f32 v[224:225], v[224:225], v[236:237]
    v_pk_add_f32 v[226:227], v[226:227], v[238:239]
    v_pk_add_f32 v[224:225], v[224:225], v[240:241]
    v_pk_add_f32 v[226:227], v[226:227], v[242:243]
    v_pk_add_f32 v[224:225], v[224:225], v[244:245]
    v_pk_add_f32 v[226:227], v[226:227], v[246:247]
    v_pk_add_f32 v[224:225], v[224:225], v[248:249]
    v_pk_add_f32 v[226:227], v[226:227], v[250:251]
    v_pk_add_f32 v[224:225], v[224:225], v[252:253]
    v_pk_add_f32 v[226:227], v[226:227], v[254:255]
    v_add_u32 v4, 159744, v3
    ds_write_b128 v4, v[224:227]
    ds_read_b32 v228, v29 offset:0
    ds_read_b32 v229, v29 offset:128
    ds_read_b32 v230, v29 offset:256
    ds_read_b32 v231, v29 offset:384
    ds_read_b32 v232, v29 offset:512
    ds_read_b32 v233, v29 offset:640
    s_waitcnt vmcnt(15)
    s_waitcnt lgkmcnt(11)
    v_mfma_f32_32x32x16_bf16 v[56:71], v[120:123], a[0:3], 0
    s_waitcnt lgkmcnt(10)
    ds_read_b128 v[140:143], v52 offset:5120
    s_add_u32 s66, s66, 4096
    buffer_load_dwordx4 a[64:67], v26, s[52:55], s66 offen offset:0 sc1
    v_mfma_f32_32x32x16_bf16 v[72:87], v[124:127], a[0:3], 0
    s_waitcnt lgkmcnt(10)
    ds_read_b128 v[120:123], v52 offset:6144
    v_mfma_f32_32x32x16_bf16 v[88:103], v[128:131], a[0:3], 0
    s_waitcnt vmcnt(15)
    s_waitcnt lgkmcnt(10)
    ds_read_b128 v[124:127], v52 offset:7168
    buffer_load_dwordx4 a[68:71], v26, s[52:55], s66 offen offset:512 sc1
    v_mfma_f32_32x32x16_bf16 v[56:71], v[132:135], a[4:7], v[56:71]
    s_waitcnt lgkmcnt(10)
    ds_read_b128 v[128:131], v52 offset:8192
    v_mfma_f32_32x32x16_bf16 v[72:87], v[136:139], a[4:7], v[72:87]
    s_waitcnt lgkmcnt(3)
    ds_read_b128 v[132:135], v52 offset:9216
    buffer_load_dwordx4 a[72:75], v26, s[52:55], s66 offen offset:1024 sc1
    v_mfma_f32_32x32x16_bf16 v[88:103], v[140:143], a[4:7], v[88:103]
    s_waitcnt vmcnt(16)
    s_waitcnt lgkmcnt(3)
    ds_read_b128 v[136:139], v52 offset:10240
    v_mfma_f32_32x32x16_bf16 v[56:71], v[120:123], a[8:11], v[56:71]
    s_waitcnt lgkmcnt(3)
    ds_read_b128 v[140:143], v52 offset:11264
    buffer_load_dwordx4 a[76:79], v26, s[52:55], s66 offen offset:1536 sc1
    v_and_b32 v234, 0xffff0000, v228
    v_lshrrev_b32 v34, 16, v228
    v_mfma_f32_32x32x16_bf16 v[72:87], v[124:127], a[8:11], v[72:87]
    s_waitcnt lgkmcnt(3)
    ds_read_b128 v[120:123], v52 offset:12288
    v_sub_f32 v228, v228, v234
    v_or_b32 v34, v34, v234
    v_cvt_pk_bf16_f32 v35, v228, v228
    v_and_b32 v234, 0xffff0000, v229
    v_lshrrev_b32 v36, 16, v229
    v_mfma_f32_32x32x16_bf16 v[88:103], v[128:131], a[8:11], v[88:103]
    s_waitcnt vmcnt(16)
    s_waitcnt lgkmcnt(3)
    ds_read_b128 v[124:127], v52 offset:13312
    buffer_load_dwordx4 a[80:83], v26, s[52:55], s66 offen offset:2048 sc1
    v_sub_f32 v229, v229, v234
    v_or_b32 v36, v36, v234
    v_cvt_pk_bf16_f32 v37, v229, v229
    v_mfma_f32_32x32x16_bf16 v[56:71], v[132:135], a[12:15], v[56:71]
    s_waitcnt lgkmcnt(3)
    ds_read_b128 v[128:131], v52 offset:14336
    v_and_b32 v234, 0xffff0000, v230
    v_lshrrev_b32 v38, 16, v230
    v_sub_f32 v230, v230, v234
    v_or_b32 v38, v38, v234
    v_cvt_pk_bf16_f32 v39, v230, v230
    v_mfma_f32_32x32x16_bf16 v[72:87], v[136:139], a[12:15], v[72:87]
    s_waitcnt lgkmcnt(3)
    ds_read_b128 v[132:135], v52 offset:15360
    buffer_load_dwordx4 a[84:87], v26, s[52:55], s66 offen offset:2560 sc1
    v_and_b32 v234, 0xffff0000, v231
    v_lshrrev_b32 v40, 16, v231
    v_sub_f32 v231, v231, v234
    v_mfma_f32_32x32x16_bf16 v[88:103], v[140:143], a[12:15], v[88:103]
    s_waitcnt vmcnt(17)
    s_waitcnt lgkmcnt(3)
    ds_read_b128 v[136:139], v52 offset:16384
    v_or_b32 v40, v40, v234
    v_cvt_pk_bf16_f32 v41, v231, v231
    v_and_b32 v234, 0xffff0000, v232
    v_lshrrev_b32 v42, 16, v232
    v_sub_f32 v232, v232, v234
    v_mfma_f32_32x32x16_bf16 v[56:71], v[120:123], a[16:19], v[56:71]
    s_waitcnt lgkmcnt(3)
    ds_read_b128 v[140:143], v52 offset:17408
    buffer_load_dwordx4 a[88:91], v26, s[52:55], s66 offen offset:3072 sc1
    v_or_b32 v42, v42, v234
    v_cvt_pk_bf16_f32 v43, v232, v232
    v_and_b32 v234, 0xffff0000, v233
    v_mfma_f32_32x32x16_bf16 v[72:87], v[124:127], a[16:19], v[72:87]
    s_waitcnt lgkmcnt(3)
    ds_read_b128 v[120:123], v52 offset:18432
    v_lshrrev_b32 v44, 16, v233
    v_sub_f32 v233, v233, v234
    v_or_b32 v44, v44, v234
    v_cvt_pk_bf16_f32 v45, v233, v233
    v_mov_b32 v46, 0
    v_mfma_f32_32x32x16_bf16 v[88:103], v[128:131], a[16:19], v[88:103]
    s_waitcnt vmcnt(17)
    s_waitcnt lgkmcnt(3)
    ds_read_b128 v[124:127], v52 offset:19456
    buffer_load_dwordx4 a[92:95], v26, s[52:55], s66 offen offset:3584 sc1
    v_mov_b32 v47, 0
    v_mfma_f32_32x32x16_bf16 v[56:71], v[132:135], a[20:23], v[56:71]
    s_waitcnt lgkmcnt(3)
    ds_read_b128 v[128:131], v52 offset:20480
    v_mfma_f32_32x32x16_bf16 v[72:87], v[136:139], a[20:23], v[72:87]
    s_waitcnt lgkmcnt(3)
    ds_read_b128 v[132:135], v52 offset:21504
    s_add_u32 s66, s66, 4096
    buffer_load_dwordx4 a[96:99], v26, s[52:55], s66 offen offset:0 sc1
    v_mfma_f32_32x32x16_bf16 v[88:103], v[140:143], a[20:23], v[88:103]
    s_waitcnt vmcnt(18)
    s_waitcnt lgkmcnt(3)
    ds_read_b128 v[136:139], v52 offset:22528
    v_mfma_f32_32x32x16_bf16 v[56:71], v[120:123], a[24:27], v[56:71]
    s_waitcnt lgkmcnt(3)
    ds_read_b128 v[140:143], v52 offset:23552
    buffer_load_dwordx4 a[100:103], v26, s[52:55], s66 offen offset:512 sc1
    v_mfma_f32_32x32x16_bf16 v[72:87], v[124:127], a[24:27], v[72:87]
    s_waitcnt lgkmcnt(3)
    ds_read_b128 v[120:123], v52 offset:24576
    v_mfma_f32_32x32x16_bf16 v[88:103], v[128:131], a[24:27], v[88:103]
    s_waitcnt vmcnt(18)
    s_waitcnt lgkmcnt(3)
    ds_read_b128 v[124:127], v52 offset:25600
    buffer_load_dwordx4 a[104:107], v26, s[52:55], s66 offen offset:1024 sc1
    v_mfma_f32_32x32x16_bf16 v[56:71], v[132:135], a[28:31], v[56:71]
    s_waitcnt lgkmcnt(3)
    ds_read_b128 v[128:131], v52 offset:26624
    v_mfma_f32_32x32x16_bf16 v[72:87], v[136:139], a[28:31], v[72:87]
    s_waitcnt lgkmcnt(3)
    ds_read_b128 v[132:135], v52 offset:27648
    buffer_load_dwordx4 a[108:111], v26, s[52:55], s66 offen offset:1536 sc1
    v_mfma_f32_32x32x16_bf16 v[88:103], v[140:143], a[28:31], v[88:103]
    s_waitcnt vmcnt(19)
    s_waitcnt lgkmcnt(3)
    ds_read_b128 v[136:139], v52 offset:28672
    v_mfma_f32_32x32x16_bf16 v[56:71], v[120:123], a[32:35], v[56:71]
    s_waitcnt lgkmcnt(3)
    ds_read_b128 v[140:143], v52 offset:29696
    buffer_load_dwordx4 a[112:115], v26, s[52:55], s66 offen offset:2048 sc1
    v_mfma_f32_32x32x16_bf16 v[72:87], v[124:127], a[32:35], v[72:87]
    s_waitcnt lgkmcnt(3)
    ds_read_b128 v[120:123], v52 offset:30720
    v_mfma_f32_32x32x16_bf16 v[88:103], v[128:131], a[32:35], v[88:103]
    s_waitcnt vmcnt(19)
    s_waitcnt lgkmcnt(3)
    ds_read_b128 v[124:127], v52 offset:31744
    buffer_load_dwordx4 a[116:119], v26, s[52:55], s66 offen offset:2560 sc1
    v_mfma_f32_32x32x16_bf16 v[56:71], v[132:135], a[36:39], v[56:71]
    s_waitcnt lgkmcnt(3)
    ds_read_b128 v[128:131], v52 offset:32768
    v_mfma_f32_32x32x16_bf16 v[72:87], v[136:139], a[36:39], v[72:87]
    s_waitcnt lgkmcnt(3)
    ds_read_b128 v[132:135], v52 offset:33792
    buffer_load_dwordx4 a[120:123], v26, s[52:55], s66 offen offset:3072 sc1
    v_mfma_f32_32x32x16_bf16 v[88:103], v[140:143], a[36:39], v[88:103]
    s_waitcnt vmcnt(20)
    s_waitcnt lgkmcnt(3)
    ds_read_b128 v[136:139], v52 offset:34816
    v_mfma_f32_32x32x16_bf16 v[56:71], v[120:123], a[40:43], v[56:71]
    s_waitcnt lgkmcnt(3)
    ds_read_b128 v[140:143], v52 offset:35840
    buffer_load_dwordx4 a[124:127], v26, s[52:55], s66 offen offset:3584 sc1
    v_mfma_f32_32x32x16_bf16 v[72:87], v[124:127], a[40:43], v[72:87]
    s_waitcnt lgkmcnt(3)
    ds_read_b128 v[120:123], v52 offset:36864
    v_mfma_f32_32x32x16_bf16 v[88:103], v[128:131], a[40:43], v[88:103]
    s_waitcnt vmcnt(20)
    s_waitcnt lgkmcnt(3)
    ds_read_b128 v[124:127], v52 offset:37888
    s_add_u32 s66, s66, 4096
    buffer_load_dwordx4 a[128:131], v26, s[52:55], s66 offen offset:0 sc1
    v_mfma_f32_32x32x16_bf16 v[56:71], v[132:135], a[44:47], v[56:71]
    s_waitcnt lgkmcnt(3)
    ds_read_b128 v[128:131], v52 offset:38912
    v_mfma_f32_32x32x16_bf16 v[72:87], v[136:139], a[44:47], v[72:87]
    s_waitcnt lgkmcnt(3)
    ds_read_b128 v[132:135], v52 offset:39936
    buffer_load_dwordx4 a[132:135], v26, s[52:55], s66 offen offset:512 sc1
    v_mfma_f32_32x32x16_bf16 v[88:103], v[140:143], a[44:47], v[88:103]
    s_waitcnt vmcnt(21)
    s_waitcnt lgkmcnt(3)
    ds_read_b128 v[136:139], v52 offset:40960
    v_mfma_f32_32x32x16_bf16 v[56:71], v[120:123], a[48:51], v[56:71]
    s_waitcnt lgkmcnt(3)
    ds_read_b128 v[140:143], v52 offset:41984
    buffer_load_dwordx4 a[136:139], v26, s[52:55], s66 offen offset:1024 sc1
    v_mfma_f32_32x32x16_bf16 v[72:87], v[124:127], a[48:51], v[72:87]
    s_waitcnt lgkmcnt(3)
    ds_read_b128 v[120:123], v52 offset:43008
    v_mfma_f32_32x32x16_bf16 v[88:103], v[128:131], a[48:51], v[88:103]
    s_waitcnt vmcnt(21)
    s_waitcnt lgkmcnt(3)
    ds_read_b128 v[124:127], v52 offset:44032
    buffer_load_dwordx4 a[140:143], v26, s[52:55], s66 offen offset:1536 sc1
    v_mfma_f32_32x32x16_bf16 v[56:71], v[132:135], a[52:55], v[56:71]
    s_waitcnt lgkmcnt(3)
    ds_read_b128 v[128:131], v52 offset:45056
    v_mfma_f32_32x32x16_bf16 v[72:87], v[136:139], a[52:55], v[72:87]
    s_waitcnt lgkmcnt(3)
    ds_read_b128 v[132:135], v52 offset:46080
    buffer_load_dwordx4 a[144:147], v26, s[52:55], s66 offen offset:2048 sc1
    v_mfma_f32_32x32x16_bf16 v[88:103], v[140:143], a[52:55], v[88:103]
    s_waitcnt vmcnt(22)
    s_waitcnt lgkmcnt(3)
    ds_read_b128 v[136:139], v52 offset:47104
    v_mfma_f32_32x32x16_bf16 v[56:71], v[120:123], a[56:59], v[56:71]
    s_waitcnt lgkmcnt(3)
    ds_read_b128 v[140:143], v52 offset:48128
    buffer_load_dwordx4 a[148:151], v26, s[52:55], s66 offen offset:2560 sc1
    v_mfma_f32_32x32x16_bf16 v[72:87], v[124:127], a[56:59], v[72:87]
    s_waitcnt lgkmcnt(3)
    ds_read_b128 v[120:123], v53 offset:0
    v_mfma_f32_32x32x16_bf16 v[88:103], v[128:131], a[56:59], v[88:103]
    s_waitcnt vmcnt(22)
    s_waitcnt lgkmcnt(3)
    ds_read_b128 v[124:127], v53 offset:1024
    buffer_load_dwordx4 a[152:155], v26, s[52:55], s66 offen offset:3072 sc1
    v_mfma_f32_32x32x16_bf16 v[56:71], v[132:135], a[60:63], v[56:71]
    s_waitcnt lgkmcnt(3)
    ds_read_b128 v[128:131], v53 offset:2048
    v_mfma_f32_32x32x16_bf16 v[72:87], v[136:139], a[60:63], v[72:87]
    s_waitcnt lgkmcnt(3)
    ds_read_b128 v[132:135], v53 offset:3072
    buffer_load_dwordx4 a[156:159], v26, s[52:55], s66 offen offset:3584 sc1
    v_mfma_f32_32x32x16_bf16 v[88:103], v[140:143], a[60:63], v[88:103]
    s_waitcnt vmcnt(23)
    s_waitcnt lgkmcnt(3)
    ds_read_b128 v[136:139], v53 offset:4096
    v_mfma_f32_32x32x16_bf16 v[56:71], v[120:123], a[64:67], v[56:71]
    s_waitcnt lgkmcnt(3)
    ds_read_b128 v[140:143], v53 offset:5120
    buffer_load_dwordx2 v[144:145], v27, s[52:55], s68 offen offset:0 sc1
    v_mfma_f32_32x32x16_bf16 v[72:87], v[124:127], a[64:67], v[72:87]
    s_waitcnt lgkmcnt(3)
    ds_read_b128 v[120:123], v53 offset:6144
    v_mfma_f32_32x32x16_bf16 v[88:103], v[128:131], a[64:67], v[88:103]
    s_waitcnt vmcnt(23)
    s_waitcnt lgkmcnt(3)
    ds_read_b128 v[124:127], v53 offset:7168
    buffer_load_dwordx2 v[146:147], v27, s[52:55], s68 offen offset:256 sc1
    v_mfma_f32_32x32x16_bf16 v[56:71], v[132:135], a[68:71], v[56:71]
    s_waitcnt lgkmcnt(3)
    ds_read_b128 v[128:131], v53 offset:8192
    v_mfma_f32_32x32x16_bf16 v[72:87], v[136:139], a[68:71], v[72:87]
    s_waitcnt lgkmcnt(3)
    ds_read_b128 v[132:135], v53 offset:9216
    buffer_load_dwordx2 v[148:149], v27, s[52:55], s68 offen offset:512 sc1
    v_mfma_f32_32x32x16_bf16 v[88:103], v[140:143], a[68:71], v[88:103]
    s_waitcnt vmcnt(24)
    s_waitcnt lgkmcnt(3)
    ds_read_b128 v[136:139], v53 offset:10240
    v_mfma_f32_32x32x16_bf16 v[56:71], v[120:123], a[72:75], v[56:71]
    s_waitcnt lgkmcnt(3)
    ds_read_b128 v[140:143], v53 offset:11264
    buffer_load_dwordx2 v[150:151], v27, s[52:55], s68 offen offset:768 sc1
    v_mfma_f32_32x32x16_bf16 v[72:87], v[124:127], a[72:75], v[72:87]
    s_waitcnt lgkmcnt(3)
    ds_read_b128 v[120:123], v53 offset:12288
    v_mfma_f32_32x32x16_bf16 v[88:103], v[128:131], a[72:75], v[88:103]
    s_waitcnt vmcnt(24)
    s_waitcnt lgkmcnt(3)
    ds_read_b128 v[124:127], v53 offset:13312
    v_mfma_f32_32x32x16_bf16 v[56:71], v[132:135], a[76:79], v[56:71]
    s_waitcnt lgkmcnt(3)
    ds_read_b128 v[128:131], v53 offset:14336
    v_mfma_f32_32x32x16_bf16 v[72:87], v[136:139], a[76:79], v[72:87]
    s_waitcnt lgkmcnt(3)
    ds_read_b128 v[132:135], v53 offset:15360
    v_mfma_f32_32x32x16_bf16 v[88:103], v[140:143], a[76:79], v[88:103]
    s_waitcnt vmcnt(23)
    s_waitcnt lgkmcnt(3)
    ds_read_b128 v[136:139], v53 offset:16384
    v_mfma_f32_32x32x16_bf16 v[56:71], v[120:123], a[80:83], v[56:71]
    s_waitcnt lgkmcnt(3)
    ds_read_b128 v[140:143], v53 offset:17408
    buffer_load_dwordx4 a[232:235], v3, s[52:55], s59 offen offset:3072 sc1
    v_mfma_f32_32x32x16_bf16 v[72:87], v[124:127], a[80:83], v[72:87]
    s_waitcnt lgkmcnt(3)
    ds_read_b128 v[120:123], v53 offset:18432
    s_add_u32 s64, s56, 0
    s_and_b32 s64, s64, 3
    v_mfma_f32_32x32x16_bf16 v[88:103], v[128:131], a[80:83], v[88:103]
    s_waitcnt vmcnt(23)
    s_waitcnt lgkmcnt(3)
    ds_read_b128 v[124:127], v53 offset:19456
    s_add_u32 s59, s3, 14336
    buffer_load_dwordx4 a[236:239], v3, s[52:55], s59 offen offset:0 sc1
    v_mfma_f32_32x32x16_bf16 v[56:71], v[132:135], a[84:87], v[56:71]
    s_waitcnt lgkmcnt(3)
    ds_read_b128 v[128:131], v53 offset:20480
    s_lshl_b32 s65, s6, 2
    s_add_u32 s64, s64, s65
    v_mfma_f32_32x32x16_bf16 v[72:87], v[136:139], a[84:87], v[72:87]
    s_waitcnt lgkmcnt(3)
    ds_read_b128 v[132:135], v53 offset:21504
    s_add_u32 s59, s3, 15360
    buffer_load_dwordx4 a[240:243], v3, s[52:55], s59 offen offset:0 sc1
    v_mfma_f32_32x32x16_bf16 v[88:103], v[140:143], a[84:87], v[88:103]
    s_waitcnt vmcnt(24)
    s_waitcnt lgkmcnt(3)
    ds_read_b128 v[136:139], v53 offset:22528
    s_mul_i32 s64, s64, 192
    s_mul_i32 s65, s56, 48
    v_mfma_f32_32x32x16_bf16 v[56:71], v[120:123], a[88:91], v[56:71]
    s_waitcnt lgkmcnt(3)
    ds_read_b128 v[140:143], v53 offset:23552
    buffer_load_dwordx4 a[244:247], v3, s[52:55], s59 offen offset:1024 sc1
    v_mfma_f32_32x32x16_bf16 v[72:87], v[124:127], a[88:91], v[72:87]
    s_waitcnt lgkmcnt(3)
    ds_read_b128 v[120:123], v53 offset:24576
    s_add_u32 s64, s64, s65
    s_lshl_b32 s64, s64, 8
    v_mfma_f32_32x32x16_bf16 v[88:103], v[128:131], a[88:91], v[88:103]
    s_waitcnt vmcnt(24)
    s_waitcnt lgkmcnt(3)
    ds_read_b128 v[124:127], v53 offset:25600
    buffer_load_dwordx4 a[248:251], v3, s[52:55], s59 offen offset:2048 sc1
    v_mfma_f32_32x32x16_bf16 v[56:71], v[132:135], a[92:95], v[56:71]
    s_waitcnt lgkmcnt(3)
    ds_read_b128 v[128:131], v53 offset:26624
    s_add_u32 s80, s64, 12582912
    s_add_u32 s64, s56, 1
    v_mfma_f32_32x32x16_bf16 v[72:87], v[136:139], a[92:95], v[72:87]
    s_waitcnt lgkmcnt(3)
    ds_read_b128 v[132:135], v53 offset:27648
    buffer_load_dwordx4 a[252:255], v3, s[52:55], s59 offen offset:3072 sc1
    v_mfma_f32_32x32x16_bf16 v[88:103], v[140:143], a[92:95], v[88:103]
    s_waitcnt vmcnt(25)
    s_waitcnt lgkmcnt(3)
    ds_read_b128 v[136:139], v53 offset:28672
    s_and_b32 s64, s64, 3
    s_lshl_b32 s65, s6, 2
    v_mfma_f32_32x32x16_bf16 v[56:71], v[120:123], a[96:99], v[56:71]
    s_waitcnt lgkmcnt(3)
    ds_read_b128 v[140:143], v53 offset:29696
    s_add_u32 s59, s3, 19456
    buffer_load_dwordx4 v[180:183], v3, s[52:55], s59 offen offset:0 sc1
    v_mfma_f32_32x32x16_bf16 v[72:87], v[124:127], a[96:99], v[72:87]
    s_waitcnt lgkmcnt(3)
    ds_read_b128 v[120:123], v53 offset:30720
    s_add_u32 s64, s64, s65
    s_mul_i32 s64, s64, 192
    v_mfma_f32_32x32x16_bf16 v[88:103], v[128:131], a[96:99], v[88:103]
    s_waitcnt vmcnt(25)
    s_waitcnt lgkmcnt(3)
    ds_read_b128 v[124:127], v53 offset:31744
    s_add_u32 s59, s3, 20480
    buffer_load_dwordx4 v[184:187], v3, s[52:55], s59 offen offset:0 sc1
    v_mfma_f32_32x32x16_bf16 v[56:71], v[132:135], a[100:103], v[56:71]
    s_waitcnt lgkmcnt(3)
    ds_read_b128 v[128:131], v53 offset:32768
    s_mul_i32 s65, s56, 48
    s_add_u32 s64, s64, s65
    v_mfma_f32_32x32x16_bf16 v[72:87], v[136:139], a[100:103], v[72:87]
    s_waitcnt lgkmcnt(3)
    ds_read_b128 v[132:135], v53 offset:33792
    buffer_load_dwordx4 v[188:191], v3, s[52:55], s59 offen offset:1024 sc1
    v_mfma_f32_32x32x16_bf16 v[88:103], v[140:143], a[100:103], v[88:103]
    s_waitcnt vmcnt(26)
    s_waitcnt lgkmcnt(3)
    ds_read_b128 v[136:139], v53 offset:34816
    s_lshl_b32 s64, s64, 8
    s_add_u32 s81, s64, 12582912
    v_mfma_f32_32x32x16_bf16 v[56:71], v[120:123], a[104:107], v[56:71]
    s_waitcnt lgkmcnt(3)
    ds_read_b128 v[140:143], v53 offset:35840
    buffer_load_dwordx4 v[192:195], v3, s[52:55], s59 offen offset:2048 sc1
    v_mfma_f32_32x32x16_bf16 v[72:87], v[124:127], a[104:107], v[72:87]
    s_waitcnt lgkmcnt(3)
    ds_read_b128 v[120:123], v53 offset:36864
    s_add_u32 s64, s56, 2
    s_and_b32 s64, s64, 3
    v_mfma_f32_32x32x16_bf16 v[88:103], v[128:131], a[104:107], v[88:103]
    s_waitcnt vmcnt(26)
    s_waitcnt lgkmcnt(3)
    ds_read_b128 v[124:127], v53 offset:37888
    buffer_load_dwordx4 v[196:199], v3, s[52:55], s59 offen offset:3072 sc1
    s_waitcnt vmcnt(11)
    v_add_f32 v144, v144, v146
    v_add_f32 v145, v145, v147
    v_mfma_f32_32x32x16_bf16 v[56:71], v[132:135], a[108:111], v[56:71]
    s_waitcnt lgkmcnt(3)
    ds_read_b128 v[128:131], v53 offset:38912
    s_lshl_b32 s65, s6, 2
    s_add_u32 s64, s64, s65
    v_add_f32 v144, v144, v148
    v_add_f32 v145, v145, v149
    v_add_f32 v144, v144, v150
    v_add_f32 v145, v145, v151
    v_mov_b32 v146, v144
    v_mfma_f32_32x32x16_bf16 v[72:87], v[136:139], a[108:111], v[72:87]
    s_waitcnt lgkmcnt(3)
    ds_read_b128 v[132:135], v53 offset:39936
    s_add_u32 s59, s3, 24576
    buffer_load_dwordx4 v[200:203], v3, s[52:55], s59 offen offset:0 sc1
    v_mov_b32 v147, v145
    v_mfma_f32_32x32x16_bf16 v[88:103], v[140:143], a[108:111], v[88:103]
    s_waitcnt lgkmcnt(3)
    ds_read_b128 v[136:139], v53 offset:40960
    s_mul_i32 s64, s64, 192
    s_mul_i32 s65, s56, 48
    v_permlane32_swap_b32 v144, v146
    v_permlane32_swap_b32 v145, v147
    v_add_f32 v144, v144, v146
    v_add_f32 v145, v145, v147
    v_mul_f32 v30, 0xbacccccd, v144
    v_mfma_f32_32x32x16_bf16 v[56:71], v[120:123], a[112:115], v[56:71]
    s_waitcnt lgkmcnt(3)
    ds_read_b128 v[140:143], v53 offset:41984
    s_add_u32 s59, s3, 25600
    buffer_load_dwordx4 v[204:207], v3, s[52:55], s59 offen offset:0 sc1
    v_mul_f32 v145, 0x3acccccd, v145
    v_fma_f32 v145, -v30, v30, v145
    v_max_f32 v145, 0, v145
    v_mfma_f32_32x32x16_bf16 v[72:87], v[124:127], a[112:115], v[72:87]
    s_waitcnt lgkmcnt(3)
    ds_read_b128 v[120:123], v53 offset:43008
    s_add_u32 s64, s64, s65
    s_lshl_b32 s64, s64, 8
    v_add_f32 v33, 0x3727c5ac, v145
    v_rsq_f32 v144, v33
    s_nop 0
    v_mul_f32 v31, 0xc0135761, v144
    v_mfma_f32_32x32x16_bf16 v[88:103], v[128:131], a[112:115], v[88:103]
    s_waitcnt lgkmcnt(3)
    ds_read_b128 v[124:127], v53 offset:44032
    buffer_load_dwordx4 v[208:211], v3, s[52:55], s59 offen offset:1024 sc1
    v_mul_f32 v145, v144, v144
    v_mul_f32 v32, 0x3d372713, v31
    v_mul_f32 v32, v32, v145
    v_mfma_f32_32x32x16_bf16 v[56:71], v[132:135], a[116:119], v[56:71]
    s_waitcnt lgkmcnt(3)
    ds_read_b128 v[128:131], v53 offset:45056
    s_add_u32 s82, s64, 12582912
    s_add_u32 s64, s56, 3
    v_and_b32 v144, 0xffff0000, v30
    v_sub_f32 v145, v30, v144
    v_cvt_pk_bf16_f32 v144, v144, v145
    v_cmp_gt_u32 vcc, 32, v0
    v_mov_b32 v50, 0
    v_mfma_f32_32x32x16_bf16 v[72:87], v[136:139], a[116:119], v[72:87]
    s_waitcnt lgkmcnt(3)
    ds_read_b128 v[132:135], v53 offset:46080
    buffer_load_dwordx4 v[212:215], v3, s[52:55], s59 offen offset:2048 sc1
    v_mov_b32 v51, 0
    v_cndmask_b32 v48, 0, v144, vcc
    v_cndmask_b32 v49, 0, v144, vcc
    v_mfma_f32_32x32x16_bf16 v[88:103], v[140:143], a[116:119], v[88:103]
    s_waitcnt lgkmcnt(3)
    ds_read_b128 v[136:139], v53 offset:47104
    s_and_b32 s64, s64, 3
    s_lshl_b32 s65, s6, 2
    v_mfma_f32_32x32x16_bf16 v[56:71], v[120:123], a[120:123], v[56:71]
    s_waitcnt lgkmcnt(3)
    ds_read_b128 v[140:143], v53 offset:48128
    buffer_load_dwordx4 v[216:219], v3, s[52:55], s59 offen offset:3072 sc1
    v_mfma_f32_32x32x16_bf16 v[72:87], v[124:127], a[120:123], v[72:87]
    s_waitcnt lgkmcnt(3)
    s_barrier
    ds_read_b128 v[120:123], v54 offset:0
    s_add_u32 s64, s64, s65
    s_mul_i32 s64, s64, 192
    v_mfma_f32_32x32x16_bf16 v[88:103], v[128:131], a[120:123], v[88:103]
    s_waitcnt lgkmcnt(3)
    ds_read_b128 v[124:127], v54 offset:1024
    s_add_u32 m0, s11, 0
    s_add_u32 s70, s10, 147456
    buffer_load_dwordx4 v3, s[52:55], s70 offen offset:0 sc1 lds
    v_mfma_f32_32x32x16_bf16 v[56:71], v[132:135], a[124:127], v[56:71]
    s_waitcnt lgkmcnt(3)
    ds_read_b128 v[128:131], v54 offset:2048
    s_mul_i32 s65, s56, 48
    s_add_u32 s64, s64, s65
    v_mfma_f32_32x32x16_bf16 v[72:87], v[136:139], a[124:127], v[72:87]
    s_waitcnt lgkmcnt(3)
    ds_read_b128 v[132:135], v54 offset:3072
    buffer_load_dwordx4 v3, s[52:55], s70 offen offset:1024 sc1 lds
    v_mfma_f32_32x32x16_bf16 v[88:103], v[140:143], a[124:127], v[88:103]
    s_waitcnt lgkmcnt(3)
    ds_read_b128 v[136:139], v54 offset:4096
    s_lshl_b32 s64, s64, 8
    s_add_u32 s83, s64, 12582912
    v_mfma_f32_32x32x16_bf16 v[56:71], v[120:123], a[128:131], v[56:71]
    s_waitcnt lgkmcnt(3)
    ds_read_b128 v[140:143], v54 offset:5120
    buffer_load_dwordx4 v3, s[52:55], s70 offen offset:2048 sc1 lds
    v_mfma_f32_32x32x16_bf16 v[72:87], v[124:127], a[128:131], v[72:87]
    s_waitcnt lgkmcnt(3)
    ds_read_b128 v[120:123], v54 offset:6144
    s_lshr_b32 s22, s6, 1
    s_lshl_b32 s22, s22, 10
    v_mfma_f32_32x32x16_bf16 v[88:103], v[128:131], a[128:131], v[88:103]
    s_waitcnt lgkmcnt(3)
    ds_read_b128 v[124:127], v54 offset:7168
    buffer_load_dwordx4 v3, s[52:55], s70 offen offset:3072 sc1 lds
    v_mfma_f32_32x32x16_bf16 v[56:71], v[132:135], a[132:135], v[56:71]
    s_waitcnt lgkmcnt(3)
    ds_read_b128 v[128:131], v54 offset:8192
    s_add_u32 s22, s22, 18972672
    v_lshlrev_b32 v14, 6, v1
    v_mfma_f32_32x32x16_bf16 v[72:87], v[136:139], a[132:135], v[72:87]
    s_waitcnt lgkmcnt(3)
    ds_read_b128 v[132:135], v54 offset:9216
    s_add_u32 m0, s11, 4096
    s_add_u32 s70, s10, 151552
    buffer_load_dwordx4 v3, s[52:55], s70 offen offset:0 sc1 lds
    v_mfma_f32_32x32x16_bf16 v[88:103], v[140:143], a[132:135], v[88:103]
    s_waitcnt lgkmcnt(3)
    ds_read_b128 v[136:139], v54 offset:10240
    v_add_u32 v6, 4096, v3
    v_add_u32 v7, 8192, v3
    v_mfma_f32_32x32x16_bf16 v[56:71], v[120:123], a[136:139], v[56:71]
    s_waitcnt lgkmcnt(3)
    ds_read_b128 v[140:143], v54 offset:11264
    buffer_load_dwordx4 v3, s[52:55], s70 offen offset:1024 sc1 lds
    v_mfma_f32_32x32x16_bf16 v[72:87], v[124:127], a[136:139], v[72:87]
    s_waitcnt lgkmcnt(3)
    ds_read_b128 v[120:123], v54 offset:12288
    v_mfma_f32_32x32x16_bf16 v[88:103], v[128:131], a[136:139], v[88:103]
    s_waitcnt lgkmcnt(3)
    ds_read_b128 v[124:127], v54 offset:13312
    s_add_u32 m0, s11, 24576
    s_add_u32 s70, s10, 172032
    buffer_load_dwordx4 v3, s[52:55], s70 offen offset:0 sc1 lds
    v_mfma_f32_32x32x16_bf16 v[56:71], v[132:135], a[140:143], v[56:71]
    s_waitcnt lgkmcnt(3)
    ds_read_b128 v[128:131], v54 offset:14336
    v_mfma_f32_32x32x16_bf16 v[72:87], v[136:139], a[140:143], v[72:87]
    s_waitcnt lgkmcnt(3)
    ds_read_b128 v[132:135], v54 offset:15360
    buffer_load_dwordx4 v3, s[52:55], s70 offen offset:1024 sc1 lds
    v_mfma_f32_32x32x16_bf16 v[88:103], v[140:143], a[140:143], v[88:103]
    s_waitcnt lgkmcnt(3)
    ds_read_b128 v[136:139], v54 offset:16384
    v_mfma_f32_32x32x16_bf16 v[56:71], v[120:123], a[144:147], v[56:71]
    s_waitcnt lgkmcnt(3)
    ds_read_b128 v[140:143], v54 offset:17408
    buffer_load_dwordx4 v3, s[52:55], s70 offen offset:2048 sc1 lds
    v_mfma_f32_32x32x16_bf16 v[72:87], v[124:127], a[144:147], v[72:87]
    s_waitcnt lgkmcnt(3)
    ds_read_b128 v[120:123], v54 offset:18432
    v_mfma_f32_32x32x16_bf16 v[88:103], v[128:131], a[144:147], v[88:103]
    s_waitcnt lgkmcnt(3)
    ds_read_b128 v[124:127], v54 offset:19456
    buffer_load_dwordx4 v3, s[52:55], s70 offen offset:3072 sc1 lds
    v_mfma_f32_32x32x16_bf16 v[56:71], v[132:135], a[148:151], v[56:71]
    s_waitcnt lgkmcnt(3)
    ds_read_b128 v[128:131], v54 offset:20480
    v_mfma_f32_32x32x16_bf16 v[72:87], v[136:139], a[148:151], v[72:87]
    s_waitcnt lgkmcnt(3)
    ds_read_b128 v[132:135], v54 offset:21504
    s_add_u32 m0, s11, 28672
    s_add_u32 s70, s10, 176128
    buffer_load_dwordx4 v3, s[52:55], s70 offen offset:0 sc1 lds
    v_mfma_f32_32x32x16_bf16 v[88:103], v[140:143], a[148:151], v[88:103]
    s_waitcnt lgkmcnt(3)
    ds_read_b128 v[136:139], v54 offset:22528
    v_mfma_f32_32x32x16_bf16 v[56:71], v[120:123], a[152:155], v[56:71]
    s_waitcnt lgkmcnt(3)
    ds_read_b128 v[140:143], v54 offset:23552
    buffer_load_dwordx4 v3, s[52:55], s70 offen offset:1024 sc1 lds
    v_mfma_f32_32x32x16_bf16 v[72:87], v[124:127], a[152:155], v[72:87]
    s_waitcnt lgkmcnt(3)
    ds_read_b128 v[120:123], v54 offset:24576
    v_mfma_f32_32x32x16_bf16 v[88:103], v[128:131], a[152:155], v[88:103]
    s_waitcnt lgkmcnt(3)
    ds_read_b128 v[124:127], v54 offset:25600
    s_add_u32 m0, s11, 49152
    s_add_u32 s70, s10, 196608
    buffer_load_dwordx4 v3, s[52:55], s70 offen offset:0 sc1 lds
    v_mfma_f32_32x32x16_bf16 v[56:71], v[132:135], a[156:159], v[56:71]
    v_mfma_f32_32x32x16_bf16 v[56:71], v[34:37], v[48:51], v[56:71]
    s_waitcnt lgkmcnt(3)
    ds_read_b128 v[128:131], v54 offset:26624
    v_mfma_f32_32x32x16_bf16 v[72:87], v[136:139], a[156:159], v[72:87]
    v_mfma_f32_32x32x16_bf16 v[72:87], v[36:39], v[48:51], v[72:87]
    s_waitcnt lgkmcnt(3)
    ds_read_b128 v[132:135], v54 offset:27648
    buffer_load_dwordx4 v3, s[52:55], s70 offen offset:1024 sc1 lds
    v_mfma_f32_32x32x16_bf16 v[88:103], v[140:143], a[156:159], v[88:103]
    v_mfma_f32_32x32x16_bf16 v[88:103], v[38:41], v[48:51], v[88:103]
    s_waitcnt lgkmcnt(3)
    ds_read_b128 v[136:139], v54 offset:28672
    s_nop 0
    v_mul_f32 v144, v56, v56
    v_mul_f32 v145, v57, v57
    v_mul_f32 v146, v58, v58
    v_mul_f32 v147, v59, v59
    v_mul_f32 v148, v64, v64
    v_mfma_f32_32x32x16_bf16 v[104:119], v[120:123], a[0:3], 0
    s_waitcnt lgkmcnt(3)
    ds_read_b128 v[140:143], v54 offset:29696
    buffer_load_dwordx4 v3, s[52:55], s70 offen offset:2048 sc1 lds
    v_mul_f32 v149, v65, v65
    v_mul_f32 v150, v66, v66
    v_mul_f32 v151, v67, v67
    v_mfma_f32_32x32x16_bf16 v[104:119], v[124:127], a[4:7], v[104:119]
    s_waitcnt lgkmcnt(3)
    ds_read_b128 v[120:123], v54 offset:30720
    v_fma_f32 v144, v144, v32, v31
    v_fma_f32 v145, v145, v32, v31
    v_fma_f32 v146, v146, v32, v31
    v_fma_f32 v147, v147, v32, v31
    v_fma_f32 v148, v148, v32, v31
    v_mfma_f32_32x32x16_bf16 v[104:119], v[128:131], a[8:11], v[104:119]
    s_waitcnt lgkmcnt(3)
    ds_read_b128 v[124:127], v54 offset:31744
    buffer_load_dwordx4 v3, s[52:55], s70 offen offset:3072 sc1 lds
    v_fma_f32 v149, v149, v32, v31
    v_fma_f32 v150, v150, v32, v31
    v_fma_f32 v151, v151, v32, v31
    v_mfma_f32_32x32x16_bf16 v[104:119], v[132:135], a[12:15], v[104:119]
    s_waitcnt lgkmcnt(3)
    ds_read_b128 v[128:131], v54 offset:32768
    v_mul_f32 v144, v144, v56
    v_mul_f32 v145, v145, v57
    v_mul_f32 v146, v146, v58
    v_mul_f32 v147, v147, v59
    v_mul_f32 v148, v148, v64
    v_mfma_f32_32x32x16_bf16 v[104:119], v[136:139], a[16:19], v[104:119]
    s_waitcnt lgkmcnt(3)
    ds_read_b128 v[132:135], v54 offset:33792
    s_add_u32 m0, s11, 53248
    s_add_u32 s70, s10, 200704
    buffer_load_dwordx4 v3, s[52:55], s70 offen offset:0 sc1 lds
    v_mul_f32 v149, v149, v65
    v_mul_f32 v150, v150, v66
    v_mul_f32 v151, v151, v67
    v_mfma_f32_32x32x16_bf16 v[104:119], v[140:143], a[20:23], v[104:119]
    s_waitcnt lgkmcnt(3)
    ds_read_b128 v[136:139], v54 offset:34816
    v_exp_f32 v144, v144
    v_mul_f32 v60, v60, v56
    v_exp_f32 v145, v145
    v_mfma_f32_32x32x16_bf16 v[104:119], v[120:123], a[24:27], v[104:119]
    s_waitcnt lgkmcnt(3)
    ds_read_b128 v[140:143], v54 offset:35840
    buffer_load_dwordx4 v3, s[52:55], s70 offen offset:1024 sc1 lds
    v_mul_f32 v61, v61, v57
    v_exp_f32 v146, v146
    v_mfma_f32_32x32x16_bf16 v[104:119], v[124:127], a[28:31], v[104:119]
    s_waitcnt lgkmcnt(3)
    ds_read_b128 v[120:123], v54 offset:36864
    v_mul_f32 v62, v62, v58
    v_exp_f32 v147, v147
    v_mul_f32 v63, v63, v59
    v_mfma_f32_32x32x16_bf16 v[104:119], v[128:131], a[32:35], v[104:119]
    s_waitcnt lgkmcnt(3)
    ds_read_b128 v[124:127], v54 offset:37888
    s_add_u32 s59, s3, 29696
    buffer_load_dwordx4 v[220:223], v3, s[52:55], s59 offen offset:0 sc1
    v_exp_f32 v148, v148
    v_mul_f32 v68, v68, v64
    v_mfma_f32_32x32x16_bf16 v[104:119], v[132:135], a[36:39], v[104:119]
    s_waitcnt lgkmcnt(3)
    ds_read_b128 v[128:131], v54 offset:38912
    v_exp_f32 v149, v149
    v_mul_f32 v69, v69, v65
    v_exp_f32 v150, v150
    v_mfma_f32_32x32x16_bf16 v[104:119], v[136:139], a[40:43], v[104:119]
    s_waitcnt lgkmcnt(3)
    ds_read_b128 v[132:135], v54 offset:39936
    s_add_u32 s59, s3, 30720
    buffer_load_dwordx4 a[160:163], v3, s[52:55], s59 offen offset:0 sc1
    v_mul_f32 v70, v70, v66
    v_exp_f32 v151, v151
    v_mfma_f32_32x32x16_bf16 v[104:119], v[140:143], a[44:47], v[104:119]
    s_waitcnt lgkmcnt(3)
    ds_read_b128 v[136:139], v54 offset:40960
    v_mul_f32 v71, v71, v67
    v_fma_f32 v144, v144, v33, v33
    v_fma_f32 v145, v145, v33, v33
    v_fma_f32 v146, v146, v33, v33
    v_fma_f32 v147, v147, v33, v33
    v_mfma_f32_32x32x16_bf16 v[104:119], v[120:123], a[48:51], v[104:119]
    s_waitcnt lgkmcnt(3)
    ds_read_b128 v[140:143], v54 offset:41984
    buffer_load_dwordx4 a[164:167], v3, s[52:55], s59 offen offset:1024 sc1
    v_fma_f32 v148, v148, v33, v33
    v_fma_f32 v149, v149, v33, v33
    v_fma_f32 v150, v150, v33, v33
    v_mfma_f32_32x32x16_bf16 v[104:119], v[124:127], a[52:55], v[104:119]
    s_waitcnt lgkmcnt(3)
    ds_read_b128 v[120:123], v54 offset:43008
    v_fma_f32 v151, v151, v33, v33
    v_rcp_f32 v144, v144
    v_rcp_f32 v145, v145
    v_mfma_f32_32x32x16_bf16 v[104:119], v[128:131], a[56:59], v[104:119]
    s_waitcnt lgkmcnt(3)
    ds_read_b128 v[124:127], v54 offset:44032
    buffer_load_dwordx4 a[168:171], v3, s[52:55], s59 offen offset:2048 sc1
    v_rcp_f32 v146, v146
    v_mfma_f32_32x32x16_bf16 v[104:119], v[132:135], a[60:63], v[104:119]
    s_waitcnt lgkmcnt(3)
    ds_read_b128 v[128:131], v54 offset:45056
    v_rcp_f32 v147, v147
    v_rcp_f32 v148, v148
    v_mfma_f32_32x32x16_bf16 v[104:119], v[136:139], a[64:67], v[104:119]
    s_waitcnt lgkmcnt(3)
    ds_read_b128 v[132:135], v54 offset:46080
    buffer_load_dwordx4 a[172:175], v3, s[52:55], s59 offen offset:3072 sc1
    v_rcp_f32 v149, v149
    v_mfma_f32_32x32x16_bf16 v[104:119], v[140:143], a[68:71], v[104:119]
    s_waitcnt lgkmcnt(3)
    ds_read_b128 v[136:139], v54 offset:47104
    v_rcp_f32 v150, v150
    v_rcp_f32 v151, v151
    v_mul_f32 v60, v60, v144
    v_mfma_f32_32x32x16_bf16 v[104:119], v[120:123], a[72:75], v[104:119]
    s_waitcnt lgkmcnt(3)
    ds_read_b128 v[140:143], v54 offset:48128
    s_add_u32 s59, s3, 34816
    buffer_load_dwordx4 a[176:179], v3, s[52:55], s59 offen offset:0 sc1
    v_mul_f32 v61, v61, v145
    v_mul_f32 v62, v62, v146
    v_mul_f32 v63, v63, v147
    v_mfma_f32_32x32x16_bf16 v[104:119], v[124:127], a[76:79], v[104:119]
    s_waitcnt lgkmcnt(3)
    s_waitcnt vmcnt(18)
    s_barrier
    ds_read_b128 v[120:123], v52 offset:0
    v_mul_f32 v68, v68, v148
    v_mul_f32 v69, v69, v149
    v_mul_f32 v70, v70, v150
    v_mul_f32 v71, v71, v151
    v_cvt_pk_bf16_f32 v152, v60, v61
    v_mfma_f32_32x32x16_bf16 v[104:119], v[128:131], a[80:83], v[104:119]
    s_waitcnt lgkmcnt(3)
    ds_read_b128 v[124:127], v52 offset:1024
    s_add_u32 m0, s11, 73728
    s_add_u32 s70, s10, 221184
    buffer_load_dwordx4 v3, s[52:55], s70 offen offset:0 sc1 lds
    v_cvt_pk_bf16_f32 v153, v62, v63
    v_cvt_pk_bf16_f32 v154, v68, v69
    v_cvt_pk_bf16_f32 v155, v70, v71
    v_mfma_f32_32x32x16_bf16 v[104:119], v[132:135], a[84:87], v[104:119]
    s_waitcnt lgkmcnt(3)
    ds_read_b128 v[128:131], v52 offset:2048
    v_mul_f32 v144, v72, v72
    v_mul_f32 v145, v73, v73
    v_mul_f32 v146, v74, v74
    v_mul_f32 v147, v75, v75
    v_mul_f32 v148, v80, v80
    v_mfma_f32_32x32x16_bf16 v[104:119], v[136:139], a[88:91], v[104:119]
    s_waitcnt lgkmcnt(3)
    ds_read_b128 v[132:135], v52 offset:3072
    buffer_store_dwordx4 v[152:155], v28, s[52:55], s67 offen offset:0 sc1
    buffer_load_dwordx4 v3, s[52:55], s70 offen offset:1024 sc1 lds
    v_mul_f32 v149, v81, v81
    v_mul_f32 v150, v82, v82
    v_mul_f32 v151, v83, v83
    v_mfma_f32_32x32x16_bf16 v[104:119], v[140:143], a[92:95], v[104:119]
    s_waitcnt lgkmcnt(3)
    ds_read_b128 v[136:139], v52 offset:4096
    v_fma_f32 v144, v144, v32, v31
    v_fma_f32 v145, v145, v32, v31
    v_fma_f32 v146, v146, v32, v31
    v_fma_f32 v147, v147, v32, v31
    v_fma_f32 v148, v148, v32, v31
    v_mfma_f32_32x32x16_bf16 v[104:119], v[120:123], a[96:99], v[104:119]
    s_waitcnt lgkmcnt(3)
    ds_read_b128 v[140:143], v52 offset:5120
    buffer_load_dwordx4 v3, s[52:55], s70 offen offset:2048 sc1 lds
    v_fma_f32 v149, v149, v32, v31
    v_fma_f32 v150, v150, v32, v31
    v_fma_f32 v151, v151, v32, v31
    v_mfma_f32_32x32x16_bf16 v[104:119], v[124:127], a[100:103], v[104:119]
    s_waitcnt lgkmcnt(3)
    ds_read_b128 v[120:123], v52 offset:6144
    v_mul_f32 v144, v144, v72
    v_mul_f32 v145, v145, v73
    v_mul_f32 v146, v146, v74
    v_mul_f32 v147, v147, v75
    v_mul_f32 v148, v148, v80
    v_mfma_f32_32x32x16_bf16 v[104:119], v[128:131], a[104:107], v[104:119]
    s_waitcnt lgkmcnt(3)
    ds_read_b128 v[124:127], v52 offset:7168
    buffer_load_dwordx4 v3, s[52:55], s70 offen offset:3072 sc1 lds
    v_mul_f32 v149, v149, v81
    v_mul_f32 v150, v150, v82
    v_mul_f32 v151, v151, v83
    v_mfma_f32_32x32x16_bf16 v[104:119], v[132:135], a[108:111], v[104:119]
    s_waitcnt lgkmcnt(3)
    ds_read_b128 v[128:131], v52 offset:8192
    v_exp_f32 v144, v144
    v_mul_f32 v76, v76, v72
    v_exp_f32 v145, v145
    v_mfma_f32_32x32x16_bf16 v[104:119], v[136:139], a[112:115], v[104:119]
    s_waitcnt lgkmcnt(3)
    ds_read_b128 v[132:135], v52 offset:9216
    s_add_u32 m0, s11, 77824
    s_add_u32 s70, s10, 225280
    buffer_load_dwordx4 v3, s[52:55], s70 offen offset:0 sc1 lds
    v_mul_f32 v77, v77, v73
    v_exp_f32 v146, v146
    v_mfma_f32_32x32x16_bf16 v[104:119], v[140:143], a[116:119], v[104:119]
    s_waitcnt lgkmcnt(3)
    ds_read_b128 v[136:139], v52 offset:10240
    v_mul_f32 v78, v78, v74
    v_exp_f32 v147, v147
    v_mul_f32 v79, v79, v75
    v_mfma_f32_32x32x16_bf16 v[104:119], v[120:123], a[120:123], v[104:119]
    s_waitcnt lgkmcnt(3)
    ds_read_b128 v[140:143], v52 offset:11264
    buffer_load_dwordx4 v3, s[52:55], s70 offen offset:1024 sc1 lds
    v_exp_f32 v148, v148
    v_mul_f32 v84, v84, v80
    v_mfma_f32_32x32x16_bf16 v[104:119], v[124:127], a[124:127], v[104:119]
    s_waitcnt lgkmcnt(3)
    ds_read_b128 v[120:123], v52 offset:12288
    v_exp_f32 v149, v149
    v_mul_f32 v85, v85, v81
    v_exp_f32 v150, v150
    v_mfma_f32_32x32x16_bf16 v[104:119], v[128:131], a[128:131], v[104:119]
    s_waitcnt lgkmcnt(3)
    ds_read_b128 v[124:127], v52 offset:13312
    s_add_u32 s59, s3, 35840
    buffer_load_dwordx4 v[168:171], v3, s[52:55], s59 offen offset:0 sc1
    v_mul_f32 v86, v86, v82
    v_exp_f32 v151, v151
    v_mfma_f32_32x32x16_bf16 v[104:119], v[132:135], a[132:135], v[104:119]
    s_waitcnt lgkmcnt(3)
    ds_read_b128 v[128:131], v52 offset:14336
    v_mul_f32 v87, v87, v83
    v_fma_f32 v144, v144, v33, v33
    v_fma_f32 v145, v145, v33, v33
    v_fma_f32 v146, v146, v33, v33
    v_fma_f32 v147, v147, v33, v33
    v_mfma_f32_32x32x16_bf16 v[104:119], v[136:139], a[136:139], v[104:119]
    s_waitcnt lgkmcnt(3)
    ds_read_b128 v[132:135], v52 offset:15360
    buffer_load_dwordx4 v[172:175], v3, s[52:55], s59 offen offset:1024 sc1
    v_fma_f32 v148, v148, v33, v33
    v_fma_f32 v149, v149, v33, v33
    v_fma_f32 v150, v150, v33, v33
    v_mfma_f32_32x32x16_bf16 v[104:119], v[140:143], a[140:143], v[104:119]
    s_waitcnt lgkmcnt(3)
    ds_read_b128 v[136:139], v52 offset:16384
    v_fma_f32 v151, v151, v33, v33
    v_rcp_f32 v144, v144
    v_rcp_f32 v145, v145
    v_mfma_f32_32x32x16_bf16 v[104:119], v[120:123], a[144:147], v[104:119]
    s_waitcnt lgkmcnt(3)
    ds_read_b128 v[140:143], v52 offset:17408
    buffer_load_dwordx4 v[176:179], v3, s[52:55], s59 offen offset:2048 sc1
    v_rcp_f32 v146, v146
    v_mfma_f32_32x32x16_bf16 v[104:119], v[124:127], a[148:151], v[104:119]
    s_waitcnt lgkmcnt(3)
    ds_read_b128 v[120:123], v52 offset:18432
    v_rcp_f32 v147, v147
    v_rcp_f32 v148, v148
    v_mfma_f32_32x32x16_bf16 v[104:119], v[128:131], a[152:155], v[104:119]
    s_waitcnt lgkmcnt(3)
    ds_read_b128 v[124:127], v52 offset:19456
    buffer_load_dwordx4 v[224:227], v3, s[52:55], s59 offen offset:3072 sc1
    v_rcp_f32 v149, v149
    v_mfma_f32_32x32x16_bf16 v[104:119], v[132:135], a[156:159], v[104:119]
    v_mfma_f32_32x32x16_bf16 v[104:119], v[40:43], v[48:51], v[104:119]
    s_waitcnt lgkmcnt(3)
    ds_read_b128 v[128:131], v52 offset:20480
    v_rcp_f32 v150, v150
    v_rcp_f32 v151, v151
    v_mul_f32 v76, v76, v144
    v_mfma_f32_32x32x16_bf16 v[56:71], v[136:139], a[0:3], 0
    s_waitcnt lgkmcnt(3)
    ds_read_b128 v[132:135], v52 offset:21504
    s_add_u32 s59, s3, 39936
    buffer_load_dwordx4 v[228:231], v3, s[52:55], s59 offen offset:0 sc1
    v_mul_f32 v77, v77, v145
    v_mul_f32 v78, v78, v146
    v_mul_f32 v79, v79, v147
    v_mfma_f32_32x32x16_bf16 v[56:71], v[140:143], a[4:7], v[56:71]
    s_waitcnt lgkmcnt(3)
    ds_read_b128 v[136:139], v52 offset:22528
    v_mul_f32 v84, v84, v148
    v_mul_f32 v85, v85, v149
    v_mul_f32 v86, v86, v150
    v_mul_f32 v87, v87, v151
    v_cvt_pk_bf16_f32 v156, v76, v77
    v_mfma_f32_32x32x16_bf16 v[56:71], v[120:123], a[8:11], v[56:71]
    s_waitcnt lgkmcnt(3)
    ds_read_b128 v[140:143], v52 offset:23552
    s_add_u32 s59, s3, 40960
    buffer_load_dwordx4 v[232:235], v3, s[52:55], s59 offen offset:0 sc1
    v_cvt_pk_bf16_f32 v157, v78, v79
    v_cvt_pk_bf16_f32 v158, v84, v85
    v_cvt_pk_bf16_f32 v159, v86, v87
    v_mfma_f32_32x32x16_bf16 v[56:71], v[124:127], a[12:15], v[56:71]
    s_waitcnt lgkmcnt(3)
    s_waitcnt vmcnt(25)
    s_barrier
    ds_read_b128 v[120:123], v52 offset:24576
    v_mul_f32 v144, v88, v88
    v_mul_f32 v145, v89, v89
    v_mul_f32 v146, v90, v90
    v_mul_f32 v147, v91, v91
    v_mul_f32 v148, v96, v96
    v_mfma_f32_32x32x16_bf16 v[56:71], v[128:131], a[16:19], v[56:71]
    s_waitcnt lgkmcnt(3)
    ds_read_b128 v[124:127], v52 offset:25600
    buffer_store_dwordx4 v[156:159], v28, s[52:55], s67 offen offset:512 sc1
    buffer_load_dwordx4 v[236:239], v3, s[52:55], s59 offen offset:1024 sc1
    v_mul_f32 v149, v97, v97
    v_mul_f32 v150, v98, v98
    v_mul_f32 v151, v99, v99
    v_mfma_f32_32x32x16_bf16 v[56:71], v[132:135], a[20:23], v[56:71]
    s_waitcnt lgkmcnt(3)
    ds_read_b128 v[128:131], v52 offset:26624
    v_fma_f32 v144, v144, v32, v31
    v_fma_f32 v145, v145, v32, v31
    v_fma_f32 v146, v146, v32, v31
    v_fma_f32 v147, v147, v32, v31
    v_fma_f32 v148, v148, v32, v31
    v_mfma_f32_32x32x16_bf16 v[56:71], v[136:139], a[24:27], v[56:71]
    s_waitcnt lgkmcnt(3)
    ds_read_b128 v[132:135], v52 offset:27648
    buffer_load_dwordx4 v[240:243], v3, s[52:55], s59 offen offset:2048 sc1
    v_fma_f32 v149, v149, v32, v31
    v_fma_f32 v150, v150, v32, v31
    v_fma_f32 v151, v151, v32, v31
    v_mfma_f32_32x32x16_bf16 v[56:71], v[140:143], a[28:31], v[56:71]
    s_waitcnt lgkmcnt(3)
    ds_read_b128 v[136:139], v52 offset:28672
    v_mul_f32 v144, v144, v88
    v_mul_f32 v145, v145, v89
    v_mul_f32 v146, v146, v90
    v_mul_f32 v147, v147, v91
    v_mul_f32 v148, v148, v96
    v_mfma_f32_32x32x16_bf16 v[56:71], v[120:123], a[32:35], v[56:71]
    s_waitcnt lgkmcnt(3)
    ds_read_b128 v[140:143], v52 offset:29696
    buffer_load_dwordx4 v[244:247], v3, s[52:55], s59 offen offset:3072 sc1
    v_mul_f32 v149, v149, v97
    v_mul_f32 v150, v150, v98
    v_mul_f32 v151, v151, v99
    v_mfma_f32_32x32x16_bf16 v[56:71], v[124:127], a[36:39], v[56:71]
    s_waitcnt lgkmcnt(3)
    ds_read_b128 v[120:123], v52 offset:30720
    v_exp_f32 v144, v144
    v_mul_f32 v92, v92, v88
    v_exp_f32 v145, v145
    v_mfma_f32_32x32x16_bf16 v[56:71], v[128:131], a[40:43], v[56:71]
    s_waitcnt lgkmcnt(3)
    ds_read_b128 v[124:127], v52 offset:31744
    s_add_u32 s59, s3, 45056
    buffer_load_dwordx4 v[248:251], v3, s[52:55], s59 offen offset:0 sc1
    v_mul_f32 v93, v93, v89
    v_exp_f32 v146, v146
    v_mfma_f32_32x32x16_bf16 v[56:71], v[132:135], a[44:47], v[56:71]
    s_waitcnt lgkmcnt(3)
    ds_read_b128 v[128:131], v52 offset:32768
    v_mul_f32 v94, v94, v90
    v_exp_f32 v147, v147
    v_mul_f32 v95, v95, v91
    v_mfma_f32_32x32x16_bf16 v[56:71], v[136:139], a[48:51], v[56:71]
    s_waitcnt lgkmcnt(3)
    ds_read_b128 v[132:135], v52 offset:33792
    s_add_u32 s59, s3, 46080
    buffer_load_dwordx4 v[252:255], v3, s[52:55], s59 offen offset:0 sc1
    v_exp_f32 v148, v148
    v_mul_f32 v100, v100, v96
    v_mfma_f32_32x32x16_bf16 v[56:71], v[140:143], a[52:55], v[56:71]
    s_waitcnt lgkmcnt(3)
    ds_read_b128 v[136:139], v52 offset:34816
    v_exp_f32 v149, v149
    v_mul_f32 v101, v101, v97
    v_exp_f32 v150, v150
    v_mfma_f32_32x32x16_bf16 v[56:71], v[120:123], a[56:59], v[56:71]
    s_waitcnt lgkmcnt(3)
    ds_read_b128 v[140:143], v52 offset:35840
    v_mul_f32 v102, v102, v98
    v_exp_f32 v151, v151
    v_mfma_f32_32x32x16_bf16 v[56:71], v[124:127], a[60:63], v[56:71]
    s_waitcnt lgkmcnt(3)
    ds_read_b128 v[120:123], v52 offset:36864
    v_mul_f32 v103, v103, v99
    v_fma_f32 v144, v144, v33, v33
    v_fma_f32 v145, v145, v33, v33
    v_fma_f32 v146, v146, v33, v33
    v_fma_f32 v147, v147, v33, v33
    v_mfma_f32_32x32x16_bf16 v[56:71], v[128:131], a[64:67], v[56:71]
    s_waitcnt lgkmcnt(3)
    ds_read_b128 v[124:127], v52 offset:37888
    v_fma_f32 v148, v148, v33, v33
    v_fma_f32 v149, v149, v33, v33
    v_fma_f32 v150, v150, v33, v33
    v_mfma_f32_32x32x16_bf16 v[56:71], v[132:135], a[68:71], v[56:71]
    s_waitcnt lgkmcnt(3)
    ds_read_b128 v[128:131], v52 offset:38912
    v_fma_f32 v151, v151, v33, v33
    v_rcp_f32 v144, v144
    v_rcp_f32 v145, v145
    v_mfma_f32_32x32x16_bf16 v[56:71], v[136:139], a[72:75], v[56:71]
    s_waitcnt lgkmcnt(3)
    ds_read_b128 v[132:135], v52 offset:39936
    v_rcp_f32 v146, v146
    v_mfma_f32_32x32x16_bf16 v[56:71], v[140:143], a[76:79], v[56:71]
    s_waitcnt lgkmcnt(3)
    ds_read_b128 v[136:139], v52 offset:40960
    v_rcp_f32 v147, v147
    v_rcp_f32 v148, v148
    v_mfma_f32_32x32x16_bf16 v[56:71], v[120:123], a[80:83], v[56:71]
    s_waitcnt lgkmcnt(3)
    ds_read_b128 v[140:143], v52 offset:41984
    v_rcp_f32 v149, v149
    v_mfma_f32_32x32x16_bf16 v[56:71], v[124:127], a[84:87], v[56:71]
    s_waitcnt lgkmcnt(3)
    ds_read_b128 v[120:123], v52 offset:43008
    v_rcp_f32 v150, v150
    v_rcp_f32 v151, v151
    v_mul_f32 v92, v92, v144
    v_mfma_f32_32x32x16_bf16 v[56:71], v[128:131], a[88:91], v[56:71]
    s_waitcnt lgkmcnt(3)
    ds_read_b128 v[124:127], v52 offset:44032
    v_mul_f32 v93, v93, v145
    v_mul_f32 v94, v94, v146
    v_mul_f32 v95, v95, v147
    v_mfma_f32_32x32x16_bf16 v[56:71], v[132:135], a[92:95], v[56:71]
    s_waitcnt lgkmcnt(3)
    ds_read_b128 v[128:131], v52 offset:45056
    v_mul_f32 v100, v100, v148
    v_mul_f32 v101, v101, v149
    v_mul_f32 v102, v102, v150
    v_mul_f32 v103, v103, v151
    v_cvt_pk_bf16_f32 v152, v92, v93
    v_mfma_f32_32x32x16_bf16 v[56:71], v[136:139], a[96:99], v[56:71]
    s_waitcnt lgkmcnt(3)
    ds_read_b128 v[132:135], v52 offset:46080
    v_cvt_pk_bf16_f32 v153, v94, v95
    v_cvt_pk_bf16_f32 v154, v100, v101
    v_cvt_pk_bf16_f32 v155, v102, v103
    v_mfma_f32_32x32x16_bf16 v[56:71], v[140:143], a[100:103], v[56:71]
    s_waitcnt lgkmcnt(3)
    ds_read_b128 v[136:139], v52 offset:47104
    v_mul_f32 v144, v104, v104
    v_mul_f32 v145, v105, v105
    v_mul_f32 v146, v106, v106
    v_mul_f32 v147, v107, v107
    v_mul_f32 v148, v112, v112
    v_mfma_f32_32x32x16_bf16 v[56:71], v[120:123], a[104:107], v[56:71]
    s_waitcnt lgkmcnt(3)
    ds_read_b128 v[140:143], v52 offset:48128
    buffer_store_dwordx4 v[152:155], v28, s[52:55], s76 offen offset:0 sc1
    v_mul_f32 v149, v113, v113
    v_mul_f32 v150, v114, v114
    v_mul_f32 v151, v115, v115
    v_mfma_f32_32x32x16_bf16 v[56:71], v[124:127], a[108:111], v[56:71]
    s_waitcnt lgkmcnt(3)
    s_waitcnt vmcnt(26)
    s_barrier
    ds_read_b128 v[120:123], v53 offset:0
    v_fma_f32 v144, v144, v32, v31
    v_fma_f32 v145, v145, v32, v31
    v_fma_f32 v146, v146, v32, v31
    v_fma_f32 v147, v147, v32, v31
    v_fma_f32 v148, v148, v32, v31
    v_mfma_f32_32x32x16_bf16 v[56:71], v[128:131], a[112:115], v[56:71]
    s_waitcnt lgkmcnt(3)
    ds_read_b128 v[124:127], v53 offset:1024
    v_fma_f32 v149, v149, v32, v31
    v_fma_f32 v150, v150, v32, v31
    v_fma_f32 v151, v151, v32, v31
    v_mfma_f32_32x32x16_bf16 v[56:71], v[132:135], a[116:119], v[56:71]
    s_waitcnt lgkmcnt(3)
    ds_read_b128 v[128:131], v53 offset:2048
    v_mul_f32 v144, v144, v104
    v_mul_f32 v145, v145, v105
    v_mul_f32 v146, v146, v106
    v_mul_f32 v147, v147, v107
    v_mul_f32 v148, v148, v112
    v_mfma_f32_32x32x16_bf16 v[56:71], v[136:139], a[120:123], v[56:71]
    s_waitcnt lgkmcnt(3)
    ds_read_b128 v[132:135], v53 offset:3072
    v_mul_f32 v149, v149, v113
    v_mul_f32 v150, v150, v114
    v_mul_f32 v151, v151, v115
    v_mfma_f32_32x32x16_bf16 v[56:71], v[140:143], a[124:127], v[56:71]
    s_waitcnt lgkmcnt(3)
    ds_read_b128 v[136:139], v53 offset:4096
    v_exp_f32 v144, v144
    v_mul_f32 v108, v108, v104
    v_exp_f32 v145, v145
    v_mfma_f32_32x32x16_bf16 v[56:71], v[120:123], a[128:131], v[56:71]
    s_waitcnt lgkmcnt(3)
    ds_read_b128 v[140:143], v53 offset:5120
    v_mul_f32 v109, v109, v105
    v_exp_f32 v146, v146
    v_mfma_f32_32x32x16_bf16 v[56:71], v[124:127], a[132:135], v[56:71]
    s_waitcnt lgkmcnt(3)
    ds_read_b128 v[120:123], v53 offset:6144
    v_mul_f32 v110, v110, v106
    v_exp_f32 v147, v147
    v_mul_f32 v111, v111, v107
    v_mfma_f32_32x32x16_bf16 v[56:71], v[128:131], a[136:139], v[56:71]
    s_waitcnt lgkmcnt(3)
    ds_read_b128 v[124:127], v53 offset:7168
    v_exp_f32 v148, v148
    v_mul_f32 v116, v116, v112
    v_mfma_f32_32x32x16_bf16 v[56:71], v[132:135], a[140:143], v[56:71]
    s_waitcnt lgkmcnt(3)
    ds_read_b128 v[128:131], v53 offset:8192
    v_exp_f32 v149, v149
    v_mul_f32 v117, v117, v113
    v_exp_f32 v150, v150
    v_mfma_f32_32x32x16_bf16 v[56:71], v[136:139], a[144:147], v[56:71]
    s_waitcnt lgkmcnt(3)
    ds_read_b128 v[132:135], v53 offset:9216
    s_waitcnt vmcnt(6)
    s_barrier
    s_cmp_lg_u32 s56, 0
    s_cbranch_scc1 L_pub_p30
    s_mul_i32 s60, s8, 16
    s_add_u32 s60, s60, s9
    s_lshl_b32 s60, s60, 6
    s_add_u32 s60, s60, 18972672
    v_mov_b32 v8, s4
    v_mov_b32 v9, s5
    v_lshlrev_b32 v10, 3, v0
    s_mov_b64 exec, 0xff
    buffer_store_dwordx2 v[8:9], v10, s[52:55], s60 offen sc1
    s_mov_b64 exec, -1
L_pub_p30:
    v_mul_f32 v118, v118, v114
    v_exp_f32 v151, v151
    v_mfma_f32_32x32x16_bf16 v[56:71], v[140:143], a[148:151], v[56:71]
    s_waitcnt lgkmcnt(3)
    ds_read_b128 v[136:139], v53 offset:10240
    v_mul_f32 v119, v119, v115
    v_fma_f32 v144, v144, v33, v33
    v_fma_f32 v145, v145, v33, v33
    v_fma_f32 v146, v146, v33, v33
    v_fma_f32 v147, v147, v33, v33
    v_mfma_f32_32x32x16_bf16 v[56:71], v[120:123], a[152:155], v[56:71]
    s_waitcnt lgkmcnt(3)
    ds_read_b128 v[140:143], v53 offset:11264
    v_fma_f32 v148, v148, v33, v33
    v_fma_f32 v149, v149, v33, v33
    v_fma_f32 v150, v150, v33, v33
    v_mfma_f32_32x32x16_bf16 v[56:71], v[124:127], a[156:159], v[56:71]
    v_mfma_f32_32x32x16_bf16 v[56:71], v[42:45], v[48:51], v[56:71]
    s_waitcnt lgkmcnt(3)
    ds_read_b128 v[120:123], v53 offset:12288
    v_fma_f32 v151, v151, v33, v33
    v_rcp_f32 v144, v144
    v_rcp_f32 v145, v145
    v_mfma_f32_32x32x16_bf16 v[72:87], v[128:131], a[0:3], 0
    s_waitcnt lgkmcnt(3)
    ds_read_b128 v[124:127], v53 offset:13312
    v_rcp_f32 v146, v146
    v_mfma_f32_32x32x16_bf16 v[72:87], v[132:135], a[4:7], v[72:87]
    s_waitcnt lgkmcnt(3)
    ds_read_b128 v[128:131], v53 offset:14336
    v_rcp_f32 v147, v147
    v_rcp_f32 v148, v148
    v_mfma_f32_32x32x16_bf16 v[72:87], v[136:139], a[8:11], v[72:87]
    s_waitcnt lgkmcnt(3)
    ds_read_b128 v[132:135], v53 offset:15360
    buffer_load_dwordx4 a[0:3], v3, s[52:55], s59 offen offset:1024 sc1
    v_rcp_f32 v149, v149
    v_mfma_f32_32x32x16_bf16 v[72:87], v[140:143], a[12:15], v[72:87]
    s_waitcnt lgkmcnt(3)
    ds_read_b128 v[136:139], v53 offset:16384
    v_rcp_f32 v150, v150
    v_rcp_f32 v151, v151
    v_mul_f32 v108, v108, v144
    v_mfma_f32_32x32x16_bf16 v[72:87], v[120:123], a[16:19], v[72:87]
    s_waitcnt lgkmcnt(3)
    ds_read_b128 v[140:143], v53 offset:17408
    buffer_load_dwordx4 a[4:7], v3, s[52:55], s59 offen offset:2048 sc1
    v_mul_f32 v109, v109, v145
    v_mul_f32 v110, v110, v146
    v_mul_f32 v111, v111, v147
    v_mfma_f32_32x32x16_bf16 v[72:87], v[124:127], a[20:23], v[72:87]
    s_waitcnt lgkmcnt(3)
    ds_read_b128 v[120:123], v53 offset:18432
    v_mul_f32 v116, v116, v148
    v_mul_f32 v117, v117, v149
    v_mul_f32 v118, v118, v150
    v_mul_f32 v119, v119, v151
    v_cvt_pk_bf16_f32 v156, v108, v109
    v_mfma_f32_32x32x16_bf16 v[72:87], v[128:131], a[24:27], v[72:87]
    s_waitcnt lgkmcnt(3)
    ds_read_b128 v[124:127], v53 offset:19456
    buffer_load_dwordx4 a[8:11], v3, s[52:55], s59 offen offset:3072 sc1
    v_cvt_pk_bf16_f32 v157, v110, v111
    v_cvt_pk_bf16_f32 v158, v116, v117
    v_cvt_pk_bf16_f32 v159, v118, v119
    v_mfma_f32_32x32x16_bf16 v[72:87], v[132:135], a[28:31], v[72:87]
    s_waitcnt lgkmcnt(3)
    ds_read_b128 v[128:131], v53 offset:20480
    v_mul_f32 v144, v56, v56
    v_mul_f32 v145, v57, v57
    v_mul_f32 v146, v58, v58
    v_mul_f32 v147, v59, v59
    v_mul_f32 v148, v64, v64
    v_mfma_f32_32x32x16_bf16 v[72:87], v[136:139], a[32:35], v[72:87]
    s_waitcnt lgkmcnt(3)
    ds_read_b128 v[132:135], v53 offset:21504
    buffer_store_dwordx4 v[156:159], v28, s[52:55], s76 offen offset:512 sc1
    s_add_u32 s59, s3, 50176
    buffer_load_dwordx4 a[12:15], v3, s[52:55], s59 offen offset:0 sc1
    v_mul_f32 v149, v65, v65
    v_mul_f32 v150, v66, v66
    v_mul_f32 v151, v67, v67
    v_mfma_f32_32x32x16_bf16 v[72:87], v[140:143], a[36:39], v[72:87]
    s_waitcnt lgkmcnt(3)
    ds_read_b128 v[136:139], v53 offset:22528
    v_fma_f32 v144, v144, v32, v31
    v_fma_f32 v145, v145, v32, v31
    v_fma_f32 v146, v146, v32, v31
    v_fma_f32 v147, v147, v32, v31
    v_fma_f32 v148, v148, v32, v31
    v_mfma_f32_32x32x16_bf16 v[72:87], v[120:123], a[40:43], v[72:87]
    s_waitcnt lgkmcnt(3)
    ds_read_b128 v[140:143], v53 offset:23552
    s_add_u32 s59, s3, 51200
    buffer_load_dwordx4 a[16:19], v3, s[52:55], s59 offen offset:0 sc1
    v_fma_f32 v149, v149, v32, v31
    v_fma_f32 v150, v150, v32, v31
    v_fma_f32 v151, v151, v32, v31
    v_mfma_f32_32x32x16_bf16 v[72:87], v[124:127], a[44:47], v[72:87]
    s_waitcnt lgkmcnt(3)
    s_barrier
    ds_read_b128 v[120:123], v53 offset:24576
    v_mul_f32 v144, v144, v56
    v_mul_f32 v145, v145, v57
    v_mul_f32 v146, v146, v58
    v_mul_f32 v147, v147, v59
    v_mul_f32 v148, v148, v64
    v_mfma_f32_32x32x16_bf16 v[72:87], v[128:131], a[48:51], v[72:87]
    s_waitcnt lgkmcnt(3)
    ds_read_b128 v[124:127], v53 offset:25600
    buffer_load_dwordx4 a[20:23], v3, s[52:55], s59 offen offset:1024 sc1
    v_mul_f32 v149, v149, v65
    v_mul_f32 v150, v150, v66
    v_mul_f32 v151, v151, v67
    v_mfma_f32_32x32x16_bf16 v[72:87], v[132:135], a[52:55], v[72:87]
    s_waitcnt lgkmcnt(3)
    ds_read_b128 v[128:131], v53 offset:26624
    v_exp_f32 v144, v144
    v_mul_f32 v60, v60, v56
    v_exp_f32 v145, v145
    v_mfma_f32_32x32x16_bf16 v[72:87], v[136:139], a[56:59], v[72:87]
    s_waitcnt lgkmcnt(3)
    ds_read_b128 v[132:135], v53 offset:27648
    buffer_load_dwordx4 a[24:27], v3, s[52:55], s59 offen offset:2048 sc1
    v_mul_f32 v61, v61, v57
    v_exp_f32 v146, v146
    v_mfma_f32_32x32x16_bf16 v[72:87], v[140:143], a[60:63], v[72:87]
    s_waitcnt lgkmcnt(3)
    ds_read_b128 v[136:139], v53 offset:28672
    v_mul_f32 v62, v62, v58
    v_exp_f32 v147, v147
    v_mul_f32 v63, v63, v59
    v_mfma_f32_32x32x16_bf16 v[72:87], v[120:123], a[64:67], v[72:87]
    s_waitcnt lgkmcnt(3)
    ds_read_b128 v[140:143], v53 offset:29696
    buffer_load_dwordx4 a[28:31], v3, s[52:55], s59 offen offset:3072 sc1
    v_exp_f32 v148, v148
    v_mul_f32 v68, v68, v64
    v_mfma_f32_32x32x16_bf16 v[72:87], v[124:127], a[68:71], v[72:87]
    s_waitcnt lgkmcnt(3)
    ds_read_b128 v[120:123], v53 offset:30720
    v_exp_f32 v149, v149
    v_mul_f32 v69, v69, v65
    v_exp_f32 v150, v150
    v_mfma_f32_32x32x16_bf16 v[72:87], v[128:131], a[72:75], v[72:87]
    s_waitcnt lgkmcnt(3)
    ds_read_b128 v[124:127], v53 offset:31744
    s_add_u32 s59, s3, 55296
    buffer_load_dwordx4 a[32:35], v3, s[52:55], s59 offen offset:0 sc1
    v_mul_f32 v70, v70, v66
    v_exp_f32 v151, v151
    v_mfma_f32_32x32x16_bf16 v[72:87], v[132:135], a[76:79], v[72:87]
    s_waitcnt lgkmcnt(3)
    ds_read_b128 v[128:131], v53 offset:32768
    v_mul_f32 v71, v71, v67
    v_fma_f32 v144, v144, v33, v33
    v_fma_f32 v145, v145, v33, v33
    v_fma_f32 v146, v146, v33, v33
    v_fma_f32 v147, v147, v33, v33
    v_mfma_f32_32x32x16_bf16 v[72:87], v[136:139], a[80:83], v[72:87]
    s_waitcnt lgkmcnt(3)
    ds_read_b128 v[132:135], v53 offset:33792
    s_add_u32 s59, s3, 56320
    buffer_load_dwordx4 a[36:39], v3, s[52:55], s59 offen offset:0 sc1
    v_fma_f32 v148, v148, v33, v33
    v_fma_f32 v149, v149, v33, v33
    v_fma_f32 v150, v150, v33, v33
    v_mfma_f32_32x32x16_bf16 v[72:87], v[140:143], a[84:87], v[72:87]
    s_waitcnt lgkmcnt(3)
    ds_read_b128 v[136:139], v53 offset:34816
    v_fma_f32 v151, v151, v33, v33
    v_rcp_f32 v144, v144
    v_rcp_f32 v145, v145
    v_mfma_f32_32x32x16_bf16 v[72:87], v[120:123], a[88:91], v[72:87]
    s_waitcnt lgkmcnt(3)
    ds_read_b128 v[140:143], v53 offset:35840
    buffer_load_dwordx4 a[40:43], v3, s[52:55], s59 offen offset:1024 sc1
    v_rcp_f32 v146, v146
    v_mfma_f32_32x32x16_bf16 v[72:87], v[124:127], a[92:95], v[72:87]
    s_waitcnt lgkmcnt(3)
    ds_read_b128 v[120:123], v53 offset:36864
    v_rcp_f32 v147, v147
    v_rcp_f32 v148, v148
    v_mfma_f32_32x32x16_bf16 v[72:87], v[128:131], a[96:99], v[72:87]
    s_waitcnt lgkmcnt(3)
    ds_read_b128 v[124:127], v53 offset:37888
    buffer_load_dwordx4 a[44:47], v3, s[52:55], s59 offen offset:2048 sc1
    v_rcp_f32 v149, v149
    v_mfma_f32_32x32x16_bf16 v[72:87], v[132:135], a[100:103], v[72:87]
    s_waitcnt lgkmcnt(3)
    ds_read_b128 v[128:131], v53 offset:38912
    v_rcp_f32 v150, v150
    v_rcp_f32 v151, v151
    v_mul_f32 v60, v60, v144
    v_mfma_f32_32x32x16_bf16 v[72:87], v[136:139], a[104:107], v[72:87]
    s_waitcnt lgkmcnt(3)
    ds_read_b128 v[132:135], v53 offset:39936
    buffer_load_dwordx4 a[48:51], v3, s[52:55], s59 offen offset:3072 sc1
    v_mul_f32 v61, v61, v145
    v_mul_f32 v62, v62, v146
    v_mul_f32 v63, v63, v147
    v_mfma_f32_32x32x16_bf16 v[72:87], v[140:143], a[108:111], v[72:87]
    s_waitcnt lgkmcnt(3)
    ds_read_b128 v[136:139], v53 offset:40960
    v_mul_f32 v68, v68, v148
    v_mul_f32 v69, v69, v149
    v_mul_f32 v70, v70, v150
    v_mul_f32 v71, v71, v151
    v_cvt_pk_bf16_f32 v152, v60, v61
    v_mfma_f32_32x32x16_bf16 v[72:87], v[120:123], a[112:115], v[72:87]
    s_waitcnt lgkmcnt(3)
    ds_read_b128 v[140:143], v53 offset:41984
    s_add_u32 s59, s3, 60416
    buffer_load_dwordx4 a[52:55], v3, s[52:55], s59 offen offset:0 sc1
    v_cvt_pk_bf16_f32 v153, v62, v63
    v_cvt_pk_bf16_f32 v154, v68, v69
    v_cvt_pk_bf16_f32 v155, v70, v71
    v_mfma_f32_32x32x16_bf16 v[72:87], v[124:127], a[116:119], v[72:87]
    s_waitcnt lgkmcnt(3)
    ds_read_b128 v[120:123], v53 offset:43008
    v_mfma_f32_32x32x16_bf16 v[72:87], v[128:131], a[120:123], v[72:87]
    s_waitcnt lgkmcnt(3)
    ds_read_b128 v[124:127], v53 offset:44032
    buffer_store_dwordx4 v[152:155], v28, s[52:55], s77 offen offset:0 sc1
    v_mfma_f32_32x32x16_bf16 v[72:87], v[132:135], a[124:127], v[72:87]
    s_waitcnt lgkmcnt(3)
    ds_read_b128 v[128:131], v53 offset:45056
    v_mfma_f32_32x32x16_bf16 v[72:87], v[136:139], a[128:131], v[72:87]
    s_waitcnt lgkmcnt(3)
    ds_read_b128 v[132:135], v53 offset:46080
    v_mfma_f32_32x32x16_bf16 v[72:87], v[140:143], a[132:135], v[72:87]
    s_waitcnt lgkmcnt(3)
    ds_read_b128 v[136:139], v53 offset:47104
    v_mfma_f32_32x32x16_bf16 v[72:87], v[120:123], a[136:139], v[72:87]
    s_waitcnt lgkmcnt(3)
    ds_read_b128 v[140:143], v53 offset:48128
    v_mfma_f32_32x32x16_bf16 v[72:87], v[124:127], a[140:143], v[72:87]
    s_waitcnt lgkmcnt(3)
    v_mfma_f32_32x32x16_bf16 v[72:87], v[128:131], a[144:147], v[72:87]
    s_waitcnt lgkmcnt(2)
    buffer_load_dwordx2 v[12:13], v14, s[52:55], s22 offen offset:0 sc1
    v_mfma_f32_32x32x16_bf16 v[72:87], v[132:135], a[148:151], v[72:87]
    s_waitcnt lgkmcnt(1)
    v_mfma_f32_32x32x16_bf16 v[72:87], v[136:139], a[152:155], v[72:87]
    s_waitcnt lgkmcnt(0)
    v_mfma_f32_32x32x16_bf16 v[72:87], v[140:143], a[156:159], v[72:87]
    v_mfma_f32_32x32x16_bf16 v[72:87], v[44:47], v[48:51], v[72:87]
    s_nop 11
    v_mul_f32 v144, v72, v72
    v_mul_f32 v145, v73, v73
    v_mul_f32 v146, v74, v74
    v_mul_f32 v147, v75, v75
    v_mul_f32 v148, v80, v80
    v_mul_f32 v149, v81, v81
    v_mul_f32 v150, v82, v82
    v_mul_f32 v151, v83, v83
    v_fma_f32 v144, v144, v32, v31
    v_fma_f32 v145, v145, v32, v31
    v_fma_f32 v146, v146, v32, v31
    v_fma_f32 v147, v147, v32, v31
    v_fma_f32 v148, v148, v32, v31
    v_fma_f32 v149, v149, v32, v31
    v_fma_f32 v150, v150, v32, v31
    v_fma_f32 v151, v151, v32, v31
    v_mul_f32 v144, v144, v72
    v_mul_f32 v145, v145, v73
    v_mul_f32 v146, v146, v74
    v_mul_f32 v147, v147, v75
    v_mul_f32 v148, v148, v80
    v_mul_f32 v149, v149, v81
    v_mul_f32 v150, v150, v82
    v_mul_f32 v151, v151, v83
    v_exp_f32 v144, v144
    v_mul_f32 v76, v76, v72
    v_exp_f32 v145, v145
    v_mul_f32 v77, v77, v73
    v_exp_f32 v146, v146
    v_mul_f32 v78, v78, v74
    v_exp_f32 v147, v147
    v_mul_f32 v79, v79, v75
    v_exp_f32 v148, v148
    v_mul_f32 v84, v84, v80
    v_exp_f32 v149, v149
    v_mul_f32 v85, v85, v81
    v_exp_f32 v150, v150
    v_mul_f32 v86, v86, v82
    v_exp_f32 v151, v151
    v_mul_f32 v87, v87, v83
    v_fma_f32 v144, v144, v33, v33
    v_fma_f32 v145, v145, v33, v33
    v_fma_f32 v146, v146, v33, v33
    v_fma_f32 v147, v147, v33, v33
    v_fma_f32 v148, v148, v33, v33
    v_fma_f32 v149, v149, v33, v33
    v_fma_f32 v150, v150, v33, v33
    v_fma_f32 v151, v151, v33, v33
    v_rcp_f32 v144, v144
    v_rcp_f32 v145, v145
    v_rcp_f32 v146, v146
    v_rcp_f32 v147, v147
    v_rcp_f32 v148, v148
    v_rcp_f32 v149, v149
    v_rcp_f32 v150, v150
    v_rcp_f32 v151, v151
    v_mul_f32 v76, v76, v144
    v_mul_f32 v77, v77, v145
    v_mul_f32 v78, v78, v146
    v_mul_f32 v79, v79, v147
    v_mul_f32 v84, v84, v148
    v_mul_f32 v85, v85, v149
    v_mul_f32 v86, v86, v150
    v_mul_f32 v87, v87, v151
    v_cvt_pk_bf16_f32 v156, v76, v77
    v_cvt_pk_bf16_f32 v157, v78, v79
    v_cvt_pk_bf16_f32 v158, v84, v85
    v_cvt_pk_bf16_f32 v159, v86, v87
    buffer_store_dwordx4 v[156:159], v28, s[52:55], s77 offen offset:2048 sc1
    s_waitcnt vmcnt(2)
    s_barrier
    s_cmp_lg_u32 s56, 0
    s_cbranch_scc1 L_pub_p31
    s_mul_i32 s60, s8, 16
    s_add_u32 s60, s60, s9
    s_lshl_b32 s60, s60, 6
    s_add_u32 s60, s60, 19005440
    v_mov_b32 v8, s4
    v_mov_b32 v9, s5
    v_lshlrev_b32 v10, 3, v0
    s_mov_b64 exec, 0xff
    buffer_store_dwordx2 v[8:9], v10, s[52:55], s60 offen sc1
    s_mov_b64 exec, -1
L_pub_p31:
    s_add_u32 s67, s22, 32768
    s_waitcnt vmcnt(1)
    s_mov_b32 s60, 0
L_chk_f3a:
    v_cmp_ne_u64 vcc, s[4:5], v[12:13]
    s_nop 0
    s_cmp_eq_u64 vcc, 0
    s_cbranch_scc1 L_ok_f3a
    buffer_load_dwordx2 v[12:13], v14, s[52:55], s22 offen offset:0 sc1
    s_waitcnt vmcnt(0)
    s_add_u32 s60, s60, 1
    s_cmp_lt_u32 s60, 0x10000
    s_cbranch_scc1 L_chk_f3a
L_ok_f3a:
    buffer_load_dwordx4 a[56:59], v3, s[52:55], s80 offen offset:0 sc1
    buffer_load_dwordx4 a[60:63], v3, s[52:55], s81 offen offset:0 sc1
    buffer_load_dwordx4 a[64:67], v3, s[52:55], s82 offen offset:0 sc1
    buffer_load_dwordx4 a[68:71], v3, s[52:55], s83 offen offset:0 sc1
    buffer_load_dwordx4 a[72:75], v3, s[52:55], s80 offen offset:1024 sc1
    buffer_load_dwordx4 a[76:79], v3, s[52:55], s81 offen offset:1024 sc1
    buffer_load_dwordx4 a[80:83], v3, s[52:55], s82 offen offset:1024 sc1
    buffer_load_dwordx4 a[84:87], v3, s[52:55], s83 offen offset:1024 sc1
    s_waitcnt vmcnt(8)
    s_barrier
    s_cmp_lg_u32 s56, 0
    s_cbranch_scc1 L_pub_p3
    s_mul_i32 s60, s8, 16
    s_add_u32 s60, s60, s9
    s_lshl_b32 s60, s60, 6
    s_add_u32 s60, s60, 19038208
    v_mov_b32 v8, s4
    v_mov_b32 v9, s5
    v_lshlrev_b32 v10, 3, v0
    s_mov_b64 exec, 0xff
    buffer_store_dwordx2 v[8:9], v10, s[52:55], s60 offen sc1
    s_mov_b64 exec, -1
L_pub_p3:
    buffer_load_dwordx4 a[88:91], v3, s[52:55], s80 offen offset:2048 sc1
    buffer_load_dwordx4 a[92:95], v3, s[52:55], s81 offen offset:2048 sc1
    buffer_load_dwordx4 a[96:99], v3, s[52:55], s82 offen offset:2048 sc1
    buffer_load_dwordx4 a[100:103], v3, s[52:55], s83 offen offset:2048 sc1
    buffer_load_dwordx4 a[104:107], v3, s[52:55], s80 offen offset:3072 sc1
    buffer_load_dwordx4 a[108:111], v3, s[52:55], s81 offen offset:3072 sc1
    buffer_load_dwordx4 a[112:115], v3, s[52:55], s82 offen offset:3072 sc1
    buffer_load_dwordx4 a[116:119], v3, s[52:55], s83 offen offset:3072 sc1
    buffer_load_dwordx2 v[12:13], v14, s[52:55], s67 offen offset:0 sc1
    v_lshlrev_b32 v30, 16, v16
    v_and_b32 v31, 0xffff0000, v16
    v_lshlrev_b32 v32, 16, v17
    v_and_b32 v33, 0xffff0000, v17
    v_lshlrev_b32 v34, 16, v18
    v_and_b32 v35, 0xffff0000, v18
    v_lshlrev_b32 v36, 16, v19
    v_and_b32 v37, 0xffff0000, v19
    v_lshlrev_b32 v38, 16, v20
    v_and_b32 v39, 0xffff0000, v20
    v_lshlrev_b32 v40, 16, v21
    v_and_b32 v41, 0xffff0000, v21
    v_lshlrev_b32 v42, 16, v22
    v_and_b32 v43, 0xffff0000, v22
    v_lshlrev_b32 v44, 16, v23
    v_and_b32 v45, 0xffff0000, v23
    v_lshlrev_b32 v46, 16, v24
    v_and_b32 v47, 0xffff0000, v24
    v_lshlrev_b32 v48, 16, v25
    v_and_b32 v49, 0xffff0000, v25
    s_waitcnt vmcnt(13)
    v_mfma_f32_16x16x32_bf16 v[30:33], a[180:183], a[56:59], v[30:33]
    s_lshl_b32 s66, s6, 2
    v_mfma_f32_16x16x32_bf16 v[50:53], a[180:183], a[60:63], 0
    s_add_u32 s66, s66, s56
    v_mfma_f32_16x16x32_bf16 v[70:73], a[180:183], a[64:67], 0
    s_mul_i32 s66, s66, 20480
    v_mfma_f32_16x16x32_bf16 v[90:93], a[180:183], a[68:71], 0
    s_mul_i32 s64, s7, 160
    v_mfma_f32_16x16x32_bf16 v[34:37], a[184:187], a[56:59], v[34:37]
    s_add_u32 s66, s66, s64
    v_mfma_f32_16x16x32_bf16 v[54:57], a[184:187], a[60:63], 0
    v_mul_u32_u24 v15, 1280, v1
    v_mfma_f32_16x16x32_bf16 v[74:77], a[184:187], a[64:67], 0
    s_movk_i32 s64, 40
    v_mfma_f32_16x16x32_bf16 v[94:97], a[184:187], a[68:71], 0
    v_mad_u32_u24 v15, v2, s64, v15
    v_mfma_f32_16x16x32_bf16 v[38:41], a[188:191], a[56:59], v[38:41]
    v_mul_u32_u24 v15, 336, v1
    v_mfma_f32_16x16x32_bf16 v[58:61], a[188:191], a[60:63], 0
    s_movk_i32 s65, 80
    v_mfma_f32_16x16x32_bf16 v[78:81], a[188:191], a[64:67], 0
    v_mad_u32_u24 v15, v2, s65, v15
    v_mfma_f32_16x16x32_bf16 v[98:101], a[188:191], a[68:71], 0
    s_add_u32 s64, s56, 0
    v_mfma_f32_16x16x32_bf16 v[42:45], a[192:195], a[56:59], v[42:45]
    s_and_b32 s64, s64, 3
    v_mfma_f32_16x16x32_bf16 v[62:65], a[192:195], a[60:63], 0
    s_mul_i32 s64, s64, 21504
    v_mfma_f32_16x16x32_bf16 v[82:85], a[192:195], a[64:67], 0
    s_add_u32 s64, s64, 0
    v_mfma_f32_16x16x32_bf16 v[102:105], a[192:195], a[68:71], 0
    v_add_u32 v26, s64, v15
    v_mfma_f32_16x16x32_bf16 v[46:49], a[196:199], a[56:59], v[46:49]
    s_add_u32 s64, s56, 1
    v_mfma_f32_16x16x32_bf16 v[66:69], a[196:199], a[60:63], 0
    s_and_b32 s64, s64, 3
    v_mfma_f32_16x16x32_bf16 v[86:89], a[196:199], a[64:67], 0
    s_mul_i32 s64, s64, 21504
    v_mfma_f32_16x16x32_bf16 v[106:109], a[196:199], a[68:71], 0
    s_add_u32 s64, s64, 5376
    s_waitcnt vmcnt(9)
    v_mfma_f32_16x16x32_bf16 v[30:33], a[200:203], a[72:75], v[30:33]
    s_waitcnt vmcnt(0)
    s_mov_b32 s60, 0
L_chk_f3b:
    v_cmp_ne_u64 vcc, s[4:5], v[12:13]
    s_nop 0
    s_cmp_eq_u64 vcc, 0
    s_cbranch_scc1 L_ok_f3b
    buffer_load_dwordx2 v[12:13], v14, s[52:55], s67 offen offset:0 sc1
    s_waitcnt vmcnt(0)
    s_add_u32 s60, s60, 1
    s_cmp_lt_u32 s60, 0x10000
    s_cbranch_scc1 L_chk_f3b
L_ok_f3b:
    v_mfma_f32_16x16x32_bf16 v[50:53], a[200:203], a[76:79], v[50:53]
    buffer_load_dwordx4 a[120:123], v6, s[52:55], s80 offen offset:0 sc1
    v_mfma_f32_16x16x32_bf16 v[70:73], a[200:203], a[80:83], v[70:73]
    v_add_u32 v27, s64, v15
    v_mfma_f32_16x16x32_bf16 v[90:93], a[200:203], a[84:87], v[90:93]
    s_add_u32 s64, s56, 2
    v_mfma_f32_16x16x32_bf16 v[34:37], a[204:207], a[72:75], v[34:37]
    s_and_b32 s64, s64, 3
    v_mfma_f32_16x16x32_bf16 v[54:57], a[204:207], a[76:79], v[54:57]
    buffer_load_dwordx4 a[124:127], v6, s[52:55], s81 offen offset:0 sc1
    v_mfma_f32_16x16x32_bf16 v[74:77], a[204:207], a[80:83], v[74:77]
    s_mul_i32 s64, s64, 21504
    v_mfma_f32_16x16x32_bf16 v[94:97], a[204:207], a[84:87], v[94:97]
    s_add_u32 s64, s64, 10752
    v_mfma_f32_16x16x32_bf16 v[38:41], a[208:211], a[72:75], v[38:41]
    v_add_u32 v28, s64, v15
    v_mfma_f32_16x16x32_bf16 v[58:61], a[208:211], a[76:79], v[58:61]
    buffer_load_dwordx4 a[128:131], v6, s[52:55], s82 offen offset:0 sc1
    v_mfma_f32_16x16x32_bf16 v[78:81], a[208:211], a[80:83], v[78:81]
    s_add_u32 s64, s56, 3
    v_mfma_f32_16x16x32_bf16 v[98:101], a[208:211], a[84:87], v[98:101]
    s_and_b32 s64, s64, 3
    v_mfma_f32_16x16x32_bf16 v[42:45], a[212:215], a[72:75], v[42:45]
    s_mul_i32 s64, s64, 21504
    v_mfma_f32_16x16x32_bf16 v[62:65], a[212:215], a[76:79], v[62:65]
    buffer_load_dwordx4 a[132:135], v6, s[52:55], s83 offen offset:0 sc1
    v_mfma_f32_16x16x32_bf16 v[82:85], a[212:215], a[80:83], v[82:85]
    s_add_u32 s64, s64, 16128
    v_mfma_f32_16x16x32_bf16 v[102:105], a[212:215], a[84:87], v[102:105]
    v_add_u32 v29, s64, v15
    v_mfma_f32_16x16x32_bf16 v[46:49], a[216:219], a[72:75], v[46:49]
    s_mul_i32 s65, s56, 21504
    v_mfma_f32_16x16x32_bf16 v[66:69], a[216:219], a[76:79], v[66:69]
    buffer_load_dwordx4 a[136:139], v6, s[52:55], s80 offen offset:1024 sc1
    v_mfma_f32_16x16x32_bf16 v[86:89], a[216:219], a[80:83], v[86:89]
    v_add_u32 v4, 0, v0
    v_mfma_f32_16x16x32_bf16 v[106:109], a[216:219], a[84:87], v[106:109]
    v_mul_u32_u24 v15, 3277, v4
    v_mfma_f32_16x16x32_bf16 v[30:33], a[220:223], a[88:91], v[30:33]
    v_lshrrev_b32 v15, 16, v15
    v_mfma_f32_16x16x32_bf16 v[50:53], a[220:223], a[92:95], v[50:53]
    buffer_load_dwordx4 a[140:143], v6, s[52:55], s81 offen offset:1024 sc1
    v_mfma_f32_16x16x32_bf16 v[70:73], a[220:223], a[96:99], v[70:73]
    v_add_lshl_u32 v16, v4, v15, 4
    v_mfma_f32_16x16x32_bf16 v[90:93], a[220:223], a[100:103], v[90:93]
    v_add_u32 v16, s65, v16
    v_mfma_f32_16x16x32_bf16 v[34:37], a[224:227], a[88:91], v[34:37]
    v_mul_u32_u24 v15, 140, v15
    v_mfma_f32_16x16x32_bf16 v[54:57], a[224:227], a[92:95], v[54:57]
    buffer_load_dwordx4 a[144:147], v6, s[52:55], s82 offen offset:1024 sc1
    v_mfma_f32_16x16x32_bf16 v[74:77], a[224:227], a[96:99], v[74:77]
    v_add_lshl_u32 v21, v4, v15, 3
    v_mfma_f32_16x16x32_bf16 v[94:97], a[224:227], a[100:103], v[94:97]
    v_add_u32 v4, 64, v0
    v_mfma_f32_16x16x32_bf16 v[38:41], a[228:231], a[88:91], v[38:41]
    v_mul_u32_u24 v15, 3277, v4
    v_mfma_f32_16x16x32_bf16 v[58:61], a[228:231], a[92:95], v[58:61]
    buffer_load_dwordx4 a[148:151], v6, s[52:55], s83 offen offset:1024 sc1
    v_mfma_f32_16x16x32_bf16 v[78:81], a[228:231], a[96:99], v[78:81]
    v_lshrrev_b32 v15, 16, v15
    v_mfma_f32_16x16x32_bf16 v[98:101], a[228:231], a[100:103], v[98:101]
    v_add_lshl_u32 v17, v4, v15, 4
    v_mfma_f32_16x16x32_bf16 v[42:45], a[232:235], a[88:91], v[42:45]
    v_add_u32 v17, s65, v17
    v_mfma_f32_16x16x32_bf16 v[62:65], a[232:235], a[92:95], v[62:65]
    buffer_load_dwordx4 v[110:113], v6, s[52:55], s80 offen offset:2048 sc1
    v_mfma_f32_16x16x32_bf16 v[82:85], a[232:235], a[96:99], v[82:85]
    v_mul_u32_u24 v15, 140, v15
    v_mfma_f32_16x16x32_bf16 v[102:105], a[232:235], a[100:103], v[102:105]
    v_add_lshl_u32 v22, v4, v15, 3
    v_mfma_f32_16x16x32_bf16 v[46:49], a[236:239], a[88:91], v[46:49]
    v_add_u32 v4, 128, v0
    v_mfma_f32_16x16x32_bf16 v[66:69], a[236:239], a[92:95], v[66:69]
    buffer_load_dwordx4 v[114:117], v6, s[52:55], s81 offen offset:2048 sc1
    v_mfma_f32_16x16x32_bf16 v[86:89], a[236:239], a[96:99], v[86:89]
    v_mul_u32_u24 v15, 3277, v4
    v_mfma_f32_16x16x32_bf16 v[106:109], a[236:239], a[100:103], v[106:109]
    v_lshrrev_b32 v15, 16, v15
    v_mfma_f32_16x16x32_bf16 v[30:33], a[240:243], a[104:107], v[30:33]
    v_add_lshl_u32 v18, v4, v15, 4
    v_mfma_f32_16x16x32_bf16 v[50:53], a[240:243], a[108:111], v[50:53]
    buffer_load_dwordx4 v[118:121], v6, s[52:55], s82 offen offset:2048 sc1
    v_mfma_f32_16x16x32_bf16 v[70:73], a[240:243], a[112:115], v[70:73]
    v_add_u32 v18, s65, v18
    v_mfma_f32_16x16x32_bf16 v[90:93], a[240:243], a[116:119], v[90:93]
    v_mul_u32_u24 v15, 140, v15
    v_mfma_f32_16x16x32_bf16 v[34:37], a[244:247], a[104:107], v[34:37]
    v_add_lshl_u32 v23, v4, v15, 3
    v_mfma_f32_16x16x32_bf16 v[54:57], a[244:247], a[108:111], v[54:57]
    buffer_load_dwordx4 v[122:125], v6, s[52:55], s83 offen offset:2048 sc1
    v_mfma_f32_16x16x32_bf16 v[74:77], a[244:247], a[112:115], v[74:77]
    v_add_u32 v4, 192, v0
    v_mfma_f32_16x16x32_bf16 v[94:97], a[244:247], a[116:119], v[94:97]
    v_mul_u32_u24 v15, 3277, v4
    v_mfma_f32_16x16x32_bf16 v[38:41], a[248:251], a[104:107], v[38:41]
    v_lshrrev_b32 v15, 16, v15
    v_mfma_f32_16x16x32_bf16 v[58:61], a[248:251], a[108:111], v[58:61]
    buffer_load_dwordx4 v[126:129], v6, s[52:55], s80 offen offset:3072 sc1
    v_mfma_f32_16x16x32_bf16 v[78:81], a[248:251], a[112:115], v[78:81]
    v_add_lshl_u32 v19, v4, v15, 4
    v_mfma_f32_16x16x32_bf16 v[98:101], a[248:251], a[116:119], v[98:101]
    v_add_u32 v19, s65, v19
    v_mfma_f32_16x16x32_bf16 v[42:45], a[252:255], a[104:107], v[42:45]
    v_mul_u32_u24 v15, 140, v15
    v_mfma_f32_16x16x32_bf16 v[62:65], a[252:255], a[108:111], v[62:65]
    buffer_load_dwordx4 v[130:133], v6, s[52:55], s81 offen offset:3072 sc1
    v_mfma_f32_16x16x32_bf16 v[82:85], a[252:255], a[112:115], v[82:85]
    v_add_lshl_u32 v24, v4, v15, 3
    v_mfma_f32_16x16x32_bf16 v[102:105], a[252:255], a[116:119], v[102:105]
    v_add_u32 v4, 256, v0
    v_mfma_f32_16x16x32_bf16 v[46:49], v[180:183], a[104:107], v[46:49]
    v_mul_u32_u24 v15, 3277, v4
    v_mfma_f32_16x16x32_bf16 v[66:69], v[180:183], a[108:111], v[66:69]
    buffer_load_dwordx4 v[134:137], v6, s[52:55], s82 offen offset:3072 sc1
    v_mfma_f32_16x16x32_bf16 v[86:89], v[180:183], a[112:115], v[86:89]
    v_lshrrev_b32 v15, 16, v15
    v_mfma_f32_16x16x32_bf16 v[106:109], v[180:183], a[116:119], v[106:109]
    v_add_lshl_u32 v20, v4, v15, 4
    s_waitcnt vmcnt(11)
    v_mfma_f32_16x16x32_bf16 v[30:33], v[184:187], a[120:123], v[30:33]
    v_add_u32 v20, s65, v20
    v_mfma_f32_16x16x32_bf16 v[50:53], v[184:187], a[124:127], v[50:53]
    buffer_load_dwordx4 v[138:141], v6, s[52:55], s83 offen offset:3072 sc1
    v_mfma_f32_16x16x32_bf16 v[70:73], v[184:187], a[128:131], v[70:73]
    v_mul_u32_u24 v15, 140, v15
    v_mfma_f32_16x16x32_bf16 v[90:93], v[184:187], a[132:135], v[90:93]
    v_add_lshl_u32 v25, v4, v15, 3
    v_mfma_f32_16x16x32_bf16 v[34:37], v[188:191], a[120:123], v[34:37]
    v_mfma_f32_16x16x32_bf16 v[54:57], v[188:191], a[124:127], v[54:57]
    buffer_load_dwordx4 v[142:145], v7, s[52:55], s80 offen offset:0 sc1
    v_mfma_f32_16x16x32_bf16 v[74:77], v[188:191], a[128:131], v[74:77]
    v_mfma_f32_16x16x32_bf16 v[94:97], v[188:191], a[132:135], v[94:97]
    v_mfma_f32_16x16x32_bf16 v[38:41], v[192:195], a[120:123], v[38:41]
    v_mfma_f32_16x16x32_bf16 v[58:61], v[192:195], a[124:127], v[58:61]
    buffer_load_dwordx4 v[146:149], v7, s[52:55], s81 offen offset:0 sc1
    v_mfma_f32_16x16x32_bf16 v[78:81], v[192:195], a[128:131], v[78:81]
    v_mfma_f32_16x16x32_bf16 v[98:101], v[192:195], a[132:135], v[98:101]
    v_mfma_f32_16x16x32_bf16 v[42:45], v[196:199], a[120:123], v[42:45]
    v_mfma_f32_16x16x32_bf16 v[62:65], v[196:199], a[124:127], v[62:65]
    buffer_load_dwordx4 v[150:153], v7, s[52:55], s82 offen offset:0 sc1
    v_mfma_f32_16x16x32_bf16 v[82:85], v[196:199], a[128:131], v[82:85]
    v_mfma_f32_16x16x32_bf16 v[102:105], v[196:199], a[132:135], v[102:105]
    v_mfma_f32_16x16x32_bf16 v[46:49], v[200:203], a[120:123], v[46:49]
    v_mfma_f32_16x16x32_bf16 v[66:69], v[200:203], a[124:127], v[66:69]
    buffer_load_dwordx4 v[154:157], v7, s[52:55], s83 offen offset:0 sc1
    v_mfma_f32_16x16x32_bf16 v[86:89], v[200:203], a[128:131], v[86:89]
    v_mfma_f32_16x16x32_bf16 v[106:109], v[200:203], a[132:135], v[106:109]
    s_waitcnt vmcnt(12)
    v_mfma_f32_16x16x32_bf16 v[30:33], v[204:207], a[136:139], v[30:33]
    v_mfma_f32_16x16x32_bf16 v[50:53], v[204:207], a[140:143], v[50:53]
    buffer_load_dwordx4 a[56:59], v7, s[52:55], s80 offen offset:1024 sc1
    v_mfma_f32_16x16x32_bf16 v[70:73], v[204:207], a[144:147], v[70:73]
    v_mfma_f32_16x16x32_bf16 v[90:93], v[204:207], a[148:151], v[90:93]
    v_mfma_f32_16x16x32_bf16 v[34:37], v[208:211], a[136:139], v[34:37]
    v_mfma_f32_16x16x32_bf16 v[54:57], v[208:211], a[140:143], v[54:57]
    buffer_load_dwordx4 a[60:63], v7, s[52:55], s81 offen offset:1024 sc1
    v_mfma_f32_16x16x32_bf16 v[74:77], v[208:211], a[144:147], v[74:77]
    v_mfma_f32_16x16x32_bf16 v[94:97], v[208:211], a[148:151], v[94:97]
    v_mfma_f32_16x16x32_bf16 v[38:41], v[212:215], a[136:139], v[38:41]
    v_mfma_f32_16x16x32_bf16 v[58:61], v[212:215], a[140:143], v[58:61]
    buffer_load_dwordx4 a[64:67], v7, s[52:55], s82 offen offset:1024 sc1
    v_mfma_f32_16x16x32_bf16 v[78:81], v[212:215], a[144:147], v[78:81]
    s_add_u32 s67, s67, 32768
    buffer_load_dwordx2 v[12:13], v14, s[52:55], s67 offen offset:0 sc1
    v_mfma_f32_16x16x32_bf16 v[98:101], v[212:215], a[148:151], v[98:101]
    v_mfma_f32_16x16x32_bf16 v[42:45], v[216:219], a[136:139], v[42:45]
    v_mfma_f32_16x16x32_bf16 v[62:65], v[216:219], a[140:143], v[62:65]
    buffer_load_dwordx4 a[68:71], v7, s[52:55], s83 offen offset:1024 sc1
    v_mfma_f32_16x16x32_bf16 v[82:85], v[216:219], a[144:147], v[82:85]
    v_mfma_f32_16x16x32_bf16 v[102:105], v[216:219], a[148:151], v[102:105]
    v_mfma_f32_16x16x32_bf16 v[46:49], v[220:223], a[136:139], v[46:49]
    v_mfma_f32_16x16x32_bf16 v[66:69], v[220:223], a[140:143], v[66:69]
    v_mfma_f32_16x16x32_bf16 v[86:89], v[220:223], a[144:147], v[86:89]
    v_mfma_f32_16x16x32_bf16 v[106:109], v[220:223], a[148:151], v[106:109]
    s_waitcnt vmcnt(13)
    v_mfma_f32_16x16x32_bf16 v[30:33], a[160:163], v[110:113], v[30:33]
    v_mfma_f32_16x16x32_bf16 v[50:53], a[160:163], v[114:117], v[50:53]
    v_mfma_f32_16x16x32_bf16 v[70:73], a[160:163], v[118:121], v[70:73]
    v_mfma_f32_16x16x32_bf16 v[90:93], a[160:163], v[122:125], v[90:93]
    v_mfma_f32_16x16x32_bf16 v[34:37], a[164:167], v[110:113], v[34:37]
    v_mfma_f32_16x16x32_bf16 v[54:57], a[164:167], v[114:117], v[54:57]
    v_mfma_f32_16x16x32_bf16 v[74:77], a[164:167], v[118:121], v[74:77]
    v_mfma_f32_16x16x32_bf16 v[94:97], a[164:167], v[122:125], v[94:97]
    v_mfma_f32_16x16x32_bf16 v[38:41], a[168:171], v[110:113], v[38:41]
    v_mfma_f32_16x16x32_bf16 v[58:61], a[168:171], v[114:117], v[58:61]
    v_mfma_f32_16x16x32_bf16 v[78:81], a[168:171], v[118:121], v[78:81]
    v_mfma_f32_16x16x32_bf16 v[98:101], a[168:171], v[122:125], v[98:101]
    v_mfma_f32_16x16x32_bf16 v[42:45], a[172:175], v[110:113], v[42:45]
    v_mfma_f32_16x16x32_bf16 v[62:65], a[172:175], v[114:117], v[62:65]
    v_mfma_f32_16x16x32_bf16 v[82:85], a[172:175], v[118:121], v[82:85]
    v_mfma_f32_16x16x32_bf16 v[102:105], a[172:175], v[122:125], v[102:105]
    v_mfma_f32_16x16x32_bf16 v[46:49], a[176:179], v[110:113], v[46:49]
    v_mfma_f32_16x16x32_bf16 v[66:69], a[176:179], v[114:117], v[66:69]
    v_mfma_f32_16x16x32_bf16 v[86:89], a[176:179], v[118:121], v[86:89]
    v_mfma_f32_16x16x32_bf16 v[106:109], a[176:179], v[122:125], v[106:109]
    s_waitcnt vmcnt(9)
    v_mfma_f32_16x16x32_bf16 v[30:33], v[168:171], v[126:129], v[30:33]
    s_waitcnt vmcnt(1)
    s_mov_b32 s60, 0
L_chk_f3c:
    v_cmp_ne_u64 vcc, s[4:5], v[12:13]
    s_nop 0
    s_cmp_eq_u64 vcc, 0
    s_cbranch_scc1 L_ok_f3c
    buffer_load_dwordx2 v[12:13], v14, s[52:55], s67 offen offset:0 sc1
    s_waitcnt vmcnt(0)
    s_add_u32 s60, s60, 1
    s_cmp_lt_u32 s60, 0x10000
    s_cbranch_scc1 L_chk_f3c
L_ok_f3c:
    v_mfma_f32_16x16x32_bf16 v[50:53], v[168:171], v[130:133], v[50:53]
    buffer_load_dwordx4 a[72:75], v7, s[52:55], s80 offen offset:2048 sc1
    v_mfma_f32_16x16x32_bf16 v[70:73], v[168:171], v[134:137], v[70:73]
    v_mfma_f32_16x16x32_bf16 v[90:93], v[168:171], v[138:141], v[90:93]
    v_mfma_f32_16x16x32_bf16 v[34:37], v[172:175], v[126:129], v[34:37]
    v_mfma_f32_16x16x32_bf16 v[54:57], v[172:175], v[130:133], v[54:57]
    buffer_load_dwordx4 a[76:79], v7, s[52:55], s81 offen offset:2048 sc1
    v_mfma_f32_16x16x32_bf16 v[74:77], v[172:175], v[134:137], v[74:77]
    v_mfma_f32_16x16x32_bf16 v[94:97], v[172:175], v[138:141], v[94:97]
    v_mfma_f32_16x16x32_bf16 v[38:41], v[176:179], v[126:129], v[38:41]
    v_mfma_f32_16x16x32_bf16 v[58:61], v[176:179], v[130:133], v[58:61]
    buffer_load_dwordx4 a[80:83], v7, s[52:55], s82 offen offset:2048 sc1
    v_mfma_f32_16x16x32_bf16 v[78:81], v[176:179], v[134:137], v[78:81]
    v_mfma_f32_16x16x32_bf16 v[98:101], v[176:179], v[138:141], v[98:101]
    v_mfma_f32_16x16x32_bf16 v[42:45], v[224:227], v[126:129], v[42:45]
    v_mfma_f32_16x16x32_bf16 v[62:65], v[224:227], v[130:133], v[62:65]
    buffer_load_dwordx4 a[84:87], v7, s[52:55], s83 offen offset:2048 sc1
    v_mfma_f32_16x16x32_bf16 v[82:85], v[224:227], v[134:137], v[82:85]
    v_mfma_f32_16x16x32_bf16 v[102:105], v[224:227], v[138:141], v[102:105]
    v_mfma_f32_16x16x32_bf16 v[46:49], v[228:231], v[126:129], v[46:49]
    v_mfma_f32_16x16x32_bf16 v[66:69], v[228:231], v[130:133], v[66:69]
    buffer_load_dwordx4 a[88:91], v7, s[52:55], s80 offen offset:3072 sc1
    v_mfma_f32_16x16x32_bf16 v[86:89], v[228:231], v[134:137], v[86:89]
    v_mfma_f32_16x16x32_bf16 v[106:109], v[228:231], v[138:141], v[106:109]
    v_mfma_f32_16x16x32_bf16 v[30:33], v[232:235], v[142:145], v[30:33]
    v_mfma_f32_16x16x32_bf16 v[50:53], v[232:235], v[146:149], v[50:53]
    buffer_load_dwordx4 a[92:95], v7, s[52:55], s81 offen offset:3072 sc1
    v_mfma_f32_16x16x32_bf16 v[70:73], v[232:235], v[150:153], v[70:73]
    v_mfma_f32_16x16x32_bf16 v[90:93], v[232:235], v[154:157], v[90:93]
    v_mfma_f32_16x16x32_bf16 v[34:37], v[236:239], v[142:145], v[34:37]
    v_mfma_f32_16x16x32_bf16 v[54:57], v[236:239], v[146:149], v[54:57]
    buffer_load_dwordx4 a[96:99], v7, s[52:55], s82 offen offset:3072 sc1
    v_mfma_f32_16x16x32_bf16 v[74:77], v[236:239], v[150:153], v[74:77]
    v_mfma_f32_16x16x32_bf16 v[94:97], v[236:239], v[154:157], v[94:97]
    v_mfma_f32_16x16x32_bf16 v[38:41], v[240:243], v[142:145], v[38:41]
    v_mfma_f32_16x16x32_bf16 v[58:61], v[240:243], v[146:149], v[58:61]
    buffer_load_dwordx4 a[100:103], v7, s[52:55], s83 offen offset:3072 sc1
    v_mfma_f32_16x16x32_bf16 v[78:81], v[240:243], v[150:153], v[78:81]
    v_mfma_f32_16x16x32_bf16 v[98:101], v[240:243], v[154:157], v[98:101]
    v_mfma_f32_16x16x32_bf16 v[42:45], v[244:247], v[142:145], v[42:45]
    v_mfma_f32_16x16x32_bf16 v[62:65], v[244:247], v[146:149], v[62:65]
    v_mfma_f32_16x16x32_bf16 v[82:85], v[244:247], v[150:153], v[82:85]
    v_mfma_f32_16x16x32_bf16 v[102:105], v[244:247], v[154:157], v[102:105]
    v_mfma_f32_16x16x32_bf16 v[46:49], v[248:251], v[142:145], v[46:49]
    v_mfma_f32_16x16x32_bf16 v[66:69], v[248:251], v[146:149], v[66:69]
    v_mfma_f32_16x16x32_bf16 v[86:89], v[248:251], v[150:153], v[86:89]
    v_mfma_f32_16x16x32_bf16 v[106:109], v[248:251], v[154:157], v[106:109]
    s_waitcnt vmcnt(8)
    v_mfma_f32_16x16x32_bf16 v[50:53], v[252:255], a[60:63], v[50:53]
    v_mfma_f32_16x16x32_bf16 v[54:57], a[0:3], a[60:63], v[54:57]
    v_mfma_f32_16x16x32_bf16 v[58:61], a[4:7], a[60:63], v[58:61]
    v_mfma_f32_16x16x32_bf16 v[62:65], a[8:11], a[60:63], v[62:65]
    v_mfma_f32_16x16x32_bf16 v[66:69], a[12:15], a[60:63], v[66:69]
    s_waitcnt vmcnt(4)
    v_mfma_f32_16x16x32_bf16 v[50:53], a[16:19], a[76:79], v[50:53]
    v_mfma_f32_16x16x32_bf16 v[54:57], a[20:23], a[76:79], v[54:57]
    v_mfma_f32_16x16x32_bf16 v[58:61], a[24:27], a[76:79], v[58:61]
    v_mfma_f32_16x16x32_bf16 v[62:65], a[28:31], a[76:79], v[62:65]
    v_mfma_f32_16x16x32_bf16 v[66:69], a[32:35], a[76:79], v[66:69]
    s_waitcnt vmcnt(0)
    v_mfma_f32_16x16x32_bf16 v[50:53], a[36:39], a[92:95], v[50:53]
    v_mfma_f32_16x16x32_bf16 v[54:57], a[40:43], a[92:95], v[54:57]
    v_mfma_f32_16x16x32_bf16 v[58:61], a[44:47], a[92:95], v[58:61]
    v_mfma_f32_16x16x32_bf16 v[62:65], a[48:51], a[92:95], v[62:65]
    v_mfma_f32_16x16x32_bf16 v[66:69], a[52:55], a[92:95], v[66:69]
    v_mfma_f32_16x16x32_bf16 v[70:73], v[252:255], a[64:67], v[70:73]
    v_mfma_f32_16x16x32_bf16 v[74:77], a[0:3], a[64:67], v[74:77]
    v_mfma_f32_16x16x32_bf16 v[78:81], a[4:7], a[64:67], v[78:81]
    v_mfma_f32_16x16x32_bf16 v[82:85], a[8:11], a[64:67], v[82:85]
    ds_write_b128 v27, v[50:53] offset:0
    v_mfma_f32_16x16x32_bf16 v[86:89], a[12:15], a[64:67], v[86:89]
    v_mfma_f32_16x16x32_bf16 v[70:73], a[16:19], a[80:83], v[70:73]
    ds_write_b128 v27, v[54:57] offset:16
    v_mfma_f32_16x16x32_bf16 v[74:77], a[20:23], a[80:83], v[74:77]
    v_mfma_f32_16x16x32_bf16 v[78:81], a[24:27], a[80:83], v[78:81]
    ds_write_b128 v27, v[58:61] offset:32
    v_mfma_f32_16x16x32_bf16 v[82:85], a[28:31], a[80:83], v[82:85]
    v_mfma_f32_16x16x32_bf16 v[86:89], a[32:35], a[80:83], v[86:89]
    ds_write_b128 v27, v[62:65] offset:48
    v_mfma_f32_16x16x32_bf16 v[70:73], a[36:39], a[96:99], v[70:73]
    v_mfma_f32_16x16x32_bf16 v[74:77], a[40:43], a[96:99], v[74:77]
    ds_write_b128 v27, v[66:69] offset:64
    v_mfma_f32_16x16x32_bf16 v[78:81], a[44:47], a[96:99], v[78:81]
    v_mfma_f32_16x16x32_bf16 v[82:85], a[48:51], a[96:99], v[82:85]
    v_mfma_f32_16x16x32_bf16 v[86:89], a[52:55], a[96:99], v[86:89]
    v_mfma_f32_16x16x32_bf16 v[90:93], v[252:255], a[68:71], v[90:93]
    v_mfma_f32_16x16x32_bf16 v[94:97], a[0:3], a[68:71], v[94:97]
    v_mfma_f32_16x16x32_bf16 v[98:101], a[4:7], a[68:71], v[98:101]
    v_mfma_f32_16x16x32_bf16 v[102:105], a[8:11], a[68:71], v[102:105]
    v_mfma_f32_16x16x32_bf16 v[106:109], a[12:15], a[68:71], v[106:109]
    ds_write_b128 v28, v[70:73] offset:0
    v_mfma_f32_16x16x32_bf16 v[90:93], a[16:19], a[84:87], v[90:93]
    v_mfma_f32_16x16x32_bf16 v[94:97], a[20:23], a[84:87], v[94:97]
    ds_write_b128 v28, v[74:77] offset:16
    v_mfma_f32_16x16x32_bf16 v[98:101], a[24:27], a[84:87], v[98:101]
    v_mfma_f32_16x16x32_bf16 v[102:105], a[28:31], a[84:87], v[102:105]
    ds_write_b128 v28, v[78:81] offset:32
    v_mfma_f32_16x16x32_bf16 v[106:109], a[32:35], a[84:87], v[106:109]
    v_mfma_f32_16x16x32_bf16 v[90:93], a[36:39], a[100:103], v[90:93]
    ds_write_b128 v28, v[82:85] offset:48
    v_mfma_f32_16x16x32_bf16 v[94:97], a[40:43], a[100:103], v[94:97]
    v_mfma_f32_16x16x32_bf16 v[98:101], a[44:47], a[100:103], v[98:101]
    ds_write_b128 v28, v[86:89] offset:64
    v_mfma_f32_16x16x32_bf16 v[102:105], a[48:51], a[100:103], v[102:105]
    v_mfma_f32_16x16x32_bf16 v[106:109], a[52:55], a[100:103], v[106:109]
    v_mfma_f32_16x16x32_bf16 v[30:33], v[252:255], a[56:59], v[30:33]
    v_mfma_f32_16x16x32_bf16 v[34:37], a[0:3], a[56:59], v[34:37]
    v_mfma_f32_16x16x32_bf16 v[38:41], a[4:7], a[56:59], v[38:41]
    v_mfma_f32_16x16x32_bf16 v[42:45], a[8:11], a[56:59], v[42:45]
    ds_write_b128 v29, v[90:93] offset:0
    v_mfma_f32_16x16x32_bf16 v[46:49], a[12:15], a[56:59], v[46:49]
    v_mfma_f32_16x16x32_bf16 v[30:33], a[16:19], a[72:75], v[30:33]
    ds_write_b128 v29, v[94:97] offset:16
    v_mfma_f32_16x16x32_bf16 v[34:37], a[20:23], a[72:75], v[34:37]
    v_mfma_f32_16x16x32_bf16 v[38:41], a[24:27], a[72:75], v[38:41]
    ds_write_b128 v29, v[98:101] offset:32
    v_mfma_f32_16x16x32_bf16 v[42:45], a[28:31], a[72:75], v[42:45]
    v_mfma_f32_16x16x32_bf16 v[46:49], a[32:35], a[72:75], v[46:49]
    ds_write_b128 v29, v[102:105] offset:48
    v_mfma_f32_16x16x32_bf16 v[30:33], a[36:39], a[88:91], v[30:33]
    v_mfma_f32_16x16x32_bf16 v[34:37], a[40:43], a[88:91], v[34:37]
    ds_write_b128 v29, v[106:109] offset:64
    v_mfma_f32_16x16x32_bf16 v[38:41], a[44:47], a[88:91], v[38:41]
    v_mfma_f32_16x16x32_bf16 v[42:45], a[48:51], a[88:91], v[42:45]
    v_mfma_f32_16x16x32_bf16 v[46:49], a[52:55], a[88:91], v[46:49]
    s_nop 2
    ds_write_b128 v26, v[30:33] offset:0
    ds_write_b128 v26, v[34:37] offset:16
    s_nop 0
    ds_write_b128 v26, v[38:41] offset:32
    ds_write_b128 v26, v[42:45] offset:48
    ds_write_b128 v26, v[46:49] offset:64
    s_waitcnt lgkmcnt(0)
    s_barrier
    ds_read_b128 v[30:33], v16 offset:0
    ds_read_b128 v[34:37], v16 offset:5376
    ds_read_b128 v[38:41], v16 offset:10752
    ds_read_b128 v[42:45], v16 offset:16128
    ds_read_b128 v[46:49], v17 offset:0
    ds_read_b128 v[50:53], v17 offset:5376
    ds_read_b128 v[54:57], v17 offset:10752
    ds_read_b128 v[58:61], v17 offset:16128
    ds_read_b128 v[62:65], v18 offset:0
    ds_read_b128 v[66:69], v18 offset:5376
    ds_read_b128 v[70:73], v18 offset:10752
    ds_read_b128 v[74:77], v18 offset:16128
    ds_read_b128 v[78:81], v19 offset:0
    ds_read_b128 v[82:85], v19 offset:5376
    ds_read_b128 v[86:89], v19 offset:10752
    ds_read_b128 v[90:93], v19 offset:16128
    ds_read_b128 v[94:97], v20 offset:0
    ds_read_b128 v[98:101], v20 offset:5376
    ds_read_b128 v[102:105], v20 offset:10752
    ds_read_b128 v[106:109], v20 offset:16128
    s_waitcnt lgkmcnt(15)
    v_pk_add_f32 v[30:31], v[30:31], v[34:35]
    v_pk_add_f32 v[32:33], v[32:33], v[36:37]
    v_pk_add_f32 v[38:39], v[38:39], v[42:43]
    v_pk_add_f32 v[40:41], v[40:41], v[44:45]
    v_pk_add_f32 v[30:31], v[30:31], v[38:39]
    v_pk_add_f32 v[32:33], v[32:33], v[40:41]
    v_cvt_pk_bf16_f32 v34, v30, v31
    v_cvt_pk_bf16_f32 v35, v32, v33
    buffer_store_dwordx2 v[34:35], v21, s[48:51], s66 offen nt
    s_waitcnt lgkmcnt(12)
    v_pk_add_f32 v[46:47], v[46:47], v[50:51]
    v_pk_add_f32 v[48:49], v[48:49], v[52:53]
    v_pk_add_f32 v[54:55], v[54:55], v[58:59]
    v_pk_add_f32 v[56:57], v[56:57], v[60:61]
    v_pk_add_f32 v[46:47], v[46:47], v[54:55]
    v_pk_add_f32 v[48:49], v[48:49], v[56:57]
    v_cvt_pk_bf16_f32 v50, v46, v47
    v_cvt_pk_bf16_f32 v51, v48, v49
    buffer_store_dwordx2 v[50:51], v22, s[48:51], s66 offen nt
    s_waitcnt lgkmcnt(8)
    v_pk_add_f32 v[62:63], v[62:63], v[66:67]
    v_pk_add_f32 v[64:65], v[64:65], v[68:69]
    v_pk_add_f32 v[70:71], v[70:71], v[74:75]
    v_pk_add_f32 v[72:73], v[72:73], v[76:77]
    v_pk_add_f32 v[62:63], v[62:63], v[70:71]
    v_pk_add_f32 v[64:65], v[64:65], v[72:73]
    v_cvt_pk_bf16_f32 v66, v62, v63
    v_cvt_pk_bf16_f32 v67, v64, v65
    buffer_store_dwordx2 v[66:67], v23, s[48:51], s66 offen nt
    s_waitcnt lgkmcnt(4)
    v_pk_add_f32 v[78:79], v[78:79], v[82:83]
    v_pk_add_f32 v[80:81], v[80:81], v[84:85]
    v_pk_add_f32 v[86:87], v[86:87], v[90:91]
    v_pk_add_f32 v[88:89], v[88:89], v[92:93]
    v_pk_add_f32 v[78:79], v[78:79], v[86:87]
    v_pk_add_f32 v[80:81], v[80:81], v[88:89]
    v_cvt_pk_bf16_f32 v82, v78, v79
    v_cvt_pk_bf16_f32 v83, v80, v81
    buffer_store_dwordx2 v[82:83], v24, s[48:51], s66 offen nt
    s_waitcnt lgkmcnt(0)
    v_pk_add_f32 v[94:95], v[94:95], v[98:99]
    v_pk_add_f32 v[96:97], v[96:97], v[100:101]
    v_pk_add_f32 v[102:103], v[102:103], v[106:107]
    v_pk_add_f32 v[104:105], v[104:105], v[108:109]
    v_pk_add_f32 v[94:95], v[94:95], v[102:103]
    v_pk_add_f32 v[96:97], v[96:97], v[104:105]
    v_cvt_pk_bf16_f32 v98, v94, v95
    v_cvt_pk_bf16_f32 v99, v96, v97
    buffer_store_dwordx2 v[98:99], v25, s[48:51], s66 offen nt
L_exit:
    s_endpgm
.section .rodata,"a"
.p2align 6
.amdhsa_kernel sequential_preLN__sliding_local_dilated__glu_gated_geglu__prompt_kernel
  .amdhsa_next_free_vgpr 512
  .amdhsa_next_free_sgpr 102
  .amdhsa_accum_offset 256
  .amdhsa_group_segment_fixed_size 0
  .amdhsa_kernarg_size 80
  .amdhsa_user_sgpr_count 2
  .amdhsa_user_sgpr_kernarg_segment_ptr 1
  .amdhsa_system_sgpr_workgroup_id_x 1
  .amdhsa_float_denorm_mode_32 3
.end_amdhsa_kernel
```
